```python
import torch

def _softmax(x, axis=-1):
    return torch.softmax(x, dim=axis)
def _gelu(x):
    return torch.nn.functional.gelu(x, approximate="tanh")
def _silu(x):
    return torch.nn.functional.silu(x)
def _sigmoid(x):
    return torch.sigmoid(x)
def _layernorm(x, axis=-1, eps=1e-5):
    m = x.mean(dim=axis, keepdim=True)
    v = x.var(dim=axis, keepdim=True, unbiased=False)
    return (x - m) / torch.sqrt(v + eps)
def _scatter_add(tgt, idx, src, axis=0):
    return tgt.clone().index_add_(axis, idx, src)
def _segment_sum(src, seg, n):
    out = torch.zeros((n,) + src.shape[1:], dtype=src.dtype)
    return out.index_add_(0, seg, src)
def _pad(x, pw):
    flat = tuple(v for pair in reversed(pw) for v in pair)
    return torch.nn.functional.pad(x, flat)

kernel_name = 'sequential_preLN__spectral_gfnet__glu_gated_swiglu__prompt'

def setup_inputs():

    _w = (lambda a: (lambda t: t.to(torch.bfloat16) if t.is_floating_point() else t)(torch.as_tensor(a)))
    def _A_setup():
        B, S, D = 1, 2048, 640
        Df = D // 2 + 1
        return {
            "x": _w((lambda *s: torch.randn(*s, dtype=torch.bfloat16) * 0.05)(B, S, D)),
            "w_r": _w((lambda *s: torch.randn(*s, dtype=torch.bfloat16) * 0.4)(S, Df) * 0.02),
            "w_i": _w((lambda *s: torch.randn(*s, dtype=torch.bfloat16) * 0.4)(S, Df) * 0.02),
        }
    _A_in = _A_setup()

    def _B_setup():
        B, S, D, F = 1, 2048, 640, 1536
        return {
            "x": _w((lambda *s: torch.randn(*s, dtype=torch.bfloat16) * 0.05)(B, S, D)),
            "w1": _w((lambda *s: torch.randn(*s, dtype=torch.bfloat16) * 0.2)(D, F) * (2.0 / D) ** 0.5),
            "w3": _w((lambda *s: torch.randn(*s, dtype=torch.bfloat16) * 0.2)(D, F) * (2.0 / D) ** 0.5),
            "w2": _w((lambda *s: torch.randn(*s, dtype=torch.bfloat16) * 0.2)(F, D) * (2.0 / F) ** 0.5),
        }
    _B_in = _B_setup()

    return {
        "A_x": _A_in["x"],
        "A_w_r": _A_in["w_r"],
        "A_w_i": _A_in["w_i"],
        "B_x": _B_in["x"],
        "B_w1": _B_in["w1"],
        "B_w3": _B_in["w3"],
        "B_w2": _B_in["w2"],
    }

def reference(A_x, A_w_r, A_w_i, B_x, B_w1, B_w3, B_w2):
    def _A_ref(x, w_r, w_i):
        B, S, D = x.shape
        X = (lambda x, axes=(-2,-1): torch.fft.rfft2(x.float(), dim=axes))(x, axes=(-2, -1))
        W = w_r + 1j * w_i
        X = X * W
        y = (lambda x, s, axes=(-2,-1): torch.fft.irfft2(x, s=s, dim=axes).to(torch.bfloat16))(X, (S, D), axes=(-2, -1))
        return y

    def _B_ref(x, w1, w3, w2):
        gate = torch.einsum("bsd,df->bsf", x, w1)
        up = torch.einsum("bsd,df->bsf", x, w3)
        h = _silu(gate) * up
        out = torch.einsum("bsf,fd->bsd", h, w2)
        return out

    x = A_x
    h = x + _A_ref(_layernorm(x, axis=-1), A_w_r, A_w_i)
    h2 = h + _B_ref(_layernorm(h, axis=-1), B_w1, B_w3, B_w2)
    return h2
```

```asm
; @launch kernel=p1_kernel grid=(416,1,1) block=(512,1,1) lds=34816
; @launch kernel=p2_kernel grid=(264,1,1) block=(512,1,1) lds=36864
; @launch kernel=p3_kernel grid=(256,1,1) block=(512,1,1) lds=43408
; @launch kernel=p4_kernel grid=(256,1,1) block=(512,1,1) lds=143360
; @launch kernel=p5_kernel grid=(256,1,1) block=(256,1,1) lds=61440
.amdgcn_target "amdgcn-amd-amdhsa--gfx950"
.text
.globl p1_kernel
.p2align 8
.type p1_kernel,@function
p1_kernel:
    s_cmp_ge_u32 s2, 416
    s_cbranch_scc1 p1_kernel_end
    s_cmp_ge_u32 s2, 256
    s_cbranch_scc1 p1_rp
    s_load_dwordx2 s[4:5], s[0:1], 0
    s_load_dwordx2 s[6:7], s[0:1], 72
    s_load_dwordx4 s[48:51], s[0:1], 8
    s_cmp_lt_u32 s2, 16
    s_cbranch_scc0 p1_kernel_pf_skip
    s_getpc_b64 s[60:61]
p1_kernel_pf:
    v_lshlrev_b32 v8, 7, v0
    v_min_u32 v8, p5_kernel_end-p1_kernel_pf, v8
    v_mov_b32 v9, s61
    v_add_co_u32 v8, vcc, s60, v8
    s_nop 1
    v_addc_co_u32 v9, vcc, 0, v9, vcc
    global_load_dword v10, v[8:9], off
    s_getpc_b64 s[60:61]
    s_add_u32 s60, s60, p3_tab@rel32@lo+4
    s_addc_u32 s61, s61, p3_tab@rel32@hi+12
    v_lshlrev_b32 v8, 7, v0
    v_min_u32 v8, 17280, v8
    v_mov_b32 v9, s61
    v_add_co_u32 v8, vcc, s60, v8
    s_nop 1
    v_addc_co_u32 v9, vcc, 0, v9, vcc
    global_load_dword v10, v[8:9], off
p1_kernel_pf_skip:
    v_and_b32 v1, 63, v0
    v_lshrrev_b32 v4, 6, v0
    s_nop 0
    v_readfirstlane_b32 s3, v4
    v_lshrrev_b32 v2, 4, v1
    v_and_b32 v3, 15, v0
    v_lshlrev_b32 v4, 2, v1
    s_nop 0
    s_lshl_b32 s8, s3, 8
    s_add_u32 s8, s8, s2
    s_mul_i32 s8, s8, 1280
    s_waitcnt lgkmcnt(0)
    s_mov_b32 s12, s4
    s_mov_b32 s13, s5
    s_mov_b32 s14, 0x280000
    s_mov_b32 s15, 0x00020000
    buffer_load_dword v11, v4, s[12:15], s8 offen offset:0
    buffer_load_dword v12, v4, s[12:15], s8 offen offset:256
    buffer_load_dword v13, v4, s[12:15], s8 offen offset:512
    buffer_load_dword v14, v4, s[12:15], s8 offen offset:768
    buffer_load_dword v15, v4, s[12:15], s8 offen offset:1024
    s_mov_b32 s16, s6
    s_mov_b32 s17, s7
    s_mov_b32 s18, 0x2c0000
    s_mov_b32 s19, 0x00020000
    s_and_b32 s52, s2, 7
    s_lshr_b32 s53, s2, 3
    s_lshl_b32 s53, s53, 6
    s_add_u32 s52, s52, s53
    s_mul_i32 s52, s52, 642
    v_lshrrev_b32 v4, 3, v1
    v_mul_u32_u24 v4, 5136, v4
    v_and_b32 v5, 7, v1
    v_lshl_add_u32 v4, v5, 7, v4
    v_add_u32 v4, s52, v4
    v_and_b32 v4, -4, v4
    v_mov_b32 v7, 0x40000000
    v_cmp_gt_u32 vcc, 6, v5
    s_nop 1
    v_cndmask_b32 v7, v7, v4, vcc
    s_cmp_eq_u32 s3, 1
    s_cselect_b32 s48, s50, s48
    s_cselect_b32 s49, s51, s49
    s_mov_b32 s52, s48
    s_mov_b32 s53, s49
    s_mov_b32 s54, 0x141000
    s_mov_b32 s55, 0x00020000
    s_cmp_lt_u32 s3, 2
    s_cbranch_scc0 p1_nopfw
    buffer_load_dword v10, v7, s[52:55], 0 offen
p1_nopfw:
    v_cvt_f32_u32 v7, v2
    v_cvt_f32_u32 v8, v3
    v_cmp_gt_u32 s[22:23], 2, v2
    v_lshlrev_b32 v85, 4, v1
    s_and_b32 s96, s3, 1
    s_lshr_b32 s97, s3, 1
    s_cmp_lt_u32 s97, 2
    s_cbranch_scc0 p1_c23
    s_cmp_eq_u32 s97, 0
    s_cbranch_scc0 p1_c1
    v_mul_f32 v9, 0x3d4ccccd, v8
    v_cmp_gt_u32 s[20:21], 3, v2
    v_mul_f32 v6, 0x41000000, v7
    s_mul_i32 s98, s96, 0x40800000
    v_add_f32 v6, s98, v6
    s_cmp_eq_u32 s96, 0
    s_cselect_b64 s[20:21], s[20:21], s[22:23]
    v_add_f32 v4, 0x00000000, v6
    v_mul_f32 v4, v4, v9
    v_cos_f32 v80, v4
    v_sin_f32 v82, -v4
    v_add_f32 v4, 0x3f800000, v6
    v_mul_f32 v4, v4, v9
    v_cos_f32 v81, v4
    v_sin_f32 v83, -v4
    v_cvt_pk_bf16_f32 v16, v80, v81
    v_cvt_pk_bf16_f32 v20, v82, v83
    v_cndmask_b32 v16, 0, v16, s[20:21]
    v_cndmask_b32 v20, 0, v20, s[20:21]
    v_add_f32 v4, 0x40000000, v6
    v_mul_f32 v4, v4, v9
    v_cos_f32 v80, v4
    v_sin_f32 v82, -v4
    v_add_f32 v4, 0x40400000, v6
    v_mul_f32 v4, v4, v9
    v_cos_f32 v81, v4
    v_sin_f32 v83, -v4
    v_cvt_pk_bf16_f32 v17, v80, v81
    v_cvt_pk_bf16_f32 v21, v82, v83
    v_cndmask_b32 v17, 0, v17, s[20:21]
    v_cndmask_b32 v21, 0, v21, s[20:21]
    s_mul_i32 s99, s96, 8
    v_add_u32 v5, s99, v85
    ds_write_b64 v5, v[16:17] offset:24576
    ds_write_b64 v5, v[20:21] offset:25600
    s_branch p1_cdone
p1_c1:
    v_mul_f32 v9, 0x3acccccd, v8
    v_mul_f32 v6, 4.0, v7
    s_mul_i32 s98, s96, 0x41800000
    v_add_f32 v6, s98, v6
    v_add_f32 v4, 0x00000000, v6
    v_mul_f32 v4, v4, v9
    v_cos_f32 v24, v4
    v_sin_f32 v32, v4
    v_add_f32 v4, 0x3f800000, v6
    v_mul_f32 v4, v4, v9
    v_cos_f32 v25, v4
    v_sin_f32 v33, v4
    v_add_f32 v4, 0x40000000, v6
    v_mul_f32 v4, v4, v9
    v_cos_f32 v26, v4
    v_sin_f32 v34, v4
    v_add_f32 v4, 0x40400000, v6
    v_mul_f32 v4, v4, v9
    v_cos_f32 v27, v4
    v_sin_f32 v35, v4
    s_mul_i32 s99, s96, 1024
    v_add_u32 v5, s99, v85
    ds_write_b128 v5, v[24:27] offset:26624
    ds_write_b128 v5, v[32:35] offset:28672
    s_branch p1_cdone
p1_c23:
    s_cmp_eq_u32 s97, 2
    s_cbranch_scc0 p1_c3
    v_mul_f32 v9, 0x3d000000, v8
    v_mul_f32 v6, 4.0, v7
    s_mul_i32 s98, s96, 0x40000000
    v_add_f32 v6, s98, v6
    v_add_f32 v4, 0x00000000, v6
    v_mul_f32 v4, v4, v9
    v_cos_f32 v80, v4
    v_sin_f32 v82, v4
    s_nop 0
    v_cvt_pk_bf16_f32 v40, v80, v82
    v_cvt_pk_bf16_f32 v44, -v82, v80
    v_add_f32 v4, 0x3f800000, v6
    v_mul_f32 v4, v4, v9
    v_cos_f32 v80, v4
    v_sin_f32 v82, v4
    s_nop 0
    v_cvt_pk_bf16_f32 v41, v80, v82
    v_cvt_pk_bf16_f32 v45, -v82, v80
    s_mul_i32 s99, s96, 8
    v_add_u32 v5, s99, v85
    ds_write_b64 v5, v[40:41] offset:30720
    ds_write_b64 v5, v[44:45] offset:31744
    s_branch p1_cdone
p1_c3:
    v_and_b32 v4, 7, v3
    v_cvt_f32_u32 v9, v4
    v_mul_f32 v9, 0x3a000000, v9
    v_lshrrev_b32 v4, 1, v2
    v_lshlrev_b32 v4, 10, v4
    v_add_u32 v4, s2, v4
    v_cvt_f32_u32 v6, v4
    s_mul_i32 s98, s96, 0x44000000
    v_add_f32 v6, s98, v6
    v_and_b32 v4, 1, v2
    v_lshrrev_b32 v5, 3, v3
    v_cmp_eq_u32 s[24:25], v4, v5
    v_add_f32 v4, 0x00000000, v6
    v_mul_f32 v4, v4, v9
    v_cos_f32 v80, v4
    v_sin_f32 v82, v4
    s_nop 0
    v_cvt_pk_bf16_f32 v72, v80, v82
    v_cvt_pk_bf16_f32 v76, -v82, v80
    v_cndmask_b32 v72, 0, v72, s[24:25]
    v_cndmask_b32 v76, 0, v76, s[24:25]
    v_add_f32 v4, 0x43800000, v6
    v_mul_f32 v4, v4, v9
    v_cos_f32 v80, v4
    v_sin_f32 v82, v4
    s_nop 0
    v_cvt_pk_bf16_f32 v73, v80, v82
    v_cvt_pk_bf16_f32 v77, -v82, v80
    v_cndmask_b32 v73, 0, v73, s[24:25]
    v_cndmask_b32 v77, 0, v77, s[24:25]
    s_mul_i32 s99, s96, 8
    v_add_u32 v5, s99, v85
    ds_write_b64 v5, v[72:73] offset:32768
    ds_write_b64 v5, v[76:77] offset:33792
p1_cdone:
    v_and_b32 v5, 1, v3
    v_sub_u32 v84, 0, v5
    v_and_b32 v84, 0x80008000, v84
    s_waitcnt lgkmcnt(0)
    s_barrier
    ds_read_b128 v[16:19], v85 offset:24576
    ds_read_b128 v[20:23], v85 offset:25600
    ds_read_b128 v[24:27], v85 offset:26624
    ds_read_b128 v[28:31], v85 offset:27648
    ds_read_b128 v[32:35], v85 offset:28672
    ds_read_b128 v[36:39], v85 offset:29696
    ds_read_b128 v[40:43], v85 offset:30720
    ds_read_b128 v[44:47], v85 offset:31744
    ds_read_b128 v[72:75], v85 offset:32768
    ds_read_b128 v[76:79], v85 offset:33792
    s_mul_i32 s9, s3, 1344
    v_lshlrev_b32 v85, 2, v1
    v_add_u32 v85, s9, v85
    v_min_u32 v4, 2, v2
    v_mov_b32 v5, 544
    v_mul_u32_u24 v4, v4, v5
    v_lshrrev_b32 v5, 2, v3
    v_lshl_add_u32 v4, v5, 6, v4
    v_and_b32 v5, 3, v3
    v_lshl_add_u32 v4, v5, 3, v4
    v_add_u32 v86, s9, v4
    v_add_u32 v5, 256, v86
    v_cndmask_b32 v87, v86, v5, s[22:23]
    s_mul_i32 s10, s3, 1536
    s_add_u32 s10, s10, 10752
    v_mov_b32 v5, 80
    v_mad_u32_u24 v4, v2, v5, v3
    v_lshlrev_b32 v4, 2, v4
    v_add_u32 v88, s10, v4
    s_add_u32 s10, s10, 1040
    v_sub_u32 v89, s10, v4
    v_cmp_ge_u32 s[26:27], 10, v3
    v_subrev_u32 v4, 1, v3
    v_cmp_ge_u32 s[28:29], 8, v4
    s_nop 3
    s_or_b32 s30, s28, 1
    s_mov_b32 s31, s29
    v_lshrrev_b32 v4, 1, v2
    v_mov_b32 v5, 6144
    v_mul_u32_u24 v4, v4, v5
    v_lshl_add_u32 v4, v3, 2, v4
    v_and_b32 v5, 1, v2
    v_lshlrev_b32 v5, 6, v5
    s_lshl_b32 s10, s3, 7
    s_add_u32 s10, s10, 10752
    v_add_u32 v4, s10, v4
    v_add_u32 v90, v4, v5
    s_cmp_eq_u32 s3, 2
    s_cselect_b64 s[32:33], -1, 0
    v_cndmask_b32 v91, v90, v4, s[32:33]
    v_and_b32 v4, 7, v3
    s_mov_b32 s10, 360448
    v_mul_lo_u32 v92, v4, s10
    v_lshrrev_b32 v4, 3, v3
    v_lshl_add_u32 v92, v4, 6, v92
    v_lshl_add_u32 v92, v2, 4, v92
    s_lshl_b32 s34, s3, 15
    s_lshl_b32 s35, s2, 7
    s_add_u32 s34, s34, s35
    s_add_u32 s35, s34, 262144
    s_waitcnt lgkmcnt(0)
    v_xor_b32 v48, v84, v40
    v_xor_b32 v52, v84, v44
    v_mov_b32 v56, v40
    v_xor_b32 v60, 0x80008000, v44
    v_mov_b32 v64, v48
    v_xor_b32 v68, 0x80008000, v52
    v_xor_b32 v49, v84, v41
    v_xor_b32 v53, v84, v45
    v_xor_b32 v57, 0x80008000, v41
    v_mov_b32 v61, v45
    v_xor_b32 v65, 0x80008000, v49
    v_mov_b32 v69, v53
    v_xor_b32 v50, v84, v42
    v_xor_b32 v54, v84, v46
    v_mov_b32 v58, v42
    v_xor_b32 v62, 0x80008000, v46
    v_mov_b32 v66, v50
    v_xor_b32 v70, 0x80008000, v54
    v_xor_b32 v51, v84, v43
    v_xor_b32 v55, v84, v47
    v_xor_b32 v59, 0x80008000, v43
    v_mov_b32 v63, v47
    v_xor_b32 v67, 0x80008000, v51
    v_mov_b32 v71, v55
    s_cmp_lt_u32 s3, 2
    s_cbranch_scc0 p1_w0
    s_waitcnt vmcnt(1)
    s_branch p1_w1
p1_w0:
    s_waitcnt vmcnt(0)
p1_w1:
    v_lshlrev_b32 v94, 16, v11
    v_and_b32 v95, 0xffff0000, v11
    v_lshlrev_b32 v96, 16, v12
    v_and_b32 v97, 0xffff0000, v12
    v_lshlrev_b32 v98, 16, v13
    v_and_b32 v99, 0xffff0000, v13
    v_lshlrev_b32 v100, 16, v14
    v_and_b32 v101, 0xffff0000, v14
    v_lshlrev_b32 v102, 16, v15
    v_and_b32 v103, 0xffff0000, v15
    v_pk_add_f32 v[6:7], v[94:95], v[96:97]
    v_pk_add_f32 v[6:7], v[6:7], v[98:99]
    v_pk_add_f32 v[6:7], v[6:7], v[100:101]
    v_pk_add_f32 v[6:7], v[6:7], v[102:103]
    v_add_f32 v6, v6, v7
    s_nop 1
    v_add_f32_dpp v6, v6, v6 quad_perm:[1,0,3,2] row_mask:0xf bank_mask:0xf
    s_nop 1
    v_add_f32_dpp v6, v6, v6 quad_perm:[2,3,0,1] row_mask:0xf bank_mask:0xf
    s_nop 1
    v_add_f32_dpp v6, v6, v6 row_half_mirror row_mask:0xf bank_mask:0xf
    s_nop 1
    v_add_f32_dpp v6, v6, v6 row_mirror row_mask:0xf bank_mask:0xf
    s_nop 1
    v_add_f32_dpp v6, v6, v6 row_bcast:15 row_mask:0xa bank_mask:0xf
    s_nop 1
    v_add_f32_dpp v6, v6, v6 row_bcast:31 row_mask:0xc bank_mask:0xf
    s_nop 0
    v_readlane_b32 s36, v6, 63
    v_mov_b32 v8, 0xbacccccd
    s_nop 0
    v_mul_f32 v9, s36, v8
    v_mul_f32 v8, s36, v8
    v_cvt_pk_bf16_f32 v80, v9, v9
    v_pk_add_f32 v[82:83], v[94:95], v[8:9]
    v_and_b32 v81, 0xffff0000, v80
    v_and_b32 v80, 0xffff0000, v80
    v_pk_mul_f32 v[6:7], v[82:83], v[82:83]
    v_pk_add_f32 v[82:83], v[96:97], v[8:9]
    v_pk_fma_f32 v[6:7], v[82:83], v[82:83], v[6:7]
    v_pk_add_f32 v[82:83], v[98:99], v[8:9]
    v_pk_fma_f32 v[6:7], v[82:83], v[82:83], v[6:7]
    v_pk_add_f32 v[82:83], v[100:101], v[8:9]
    v_pk_fma_f32 v[6:7], v[82:83], v[82:83], v[6:7]
    v_pk_add_f32 v[82:83], v[102:103], v[8:9]
    v_pk_fma_f32 v[6:7], v[82:83], v[82:83], v[6:7]
    v_add_f32 v6, v6, v7
    v_pk_add_f32 v[94:95], v[94:95], v[80:81]
    v_pk_add_f32 v[96:97], v[96:97], v[80:81]
    v_pk_add_f32 v[98:99], v[98:99], v[80:81]
    v_pk_add_f32 v[100:101], v[100:101], v[80:81]
    v_pk_add_f32 v[102:103], v[102:103], v[80:81]
    v_add_f32_dpp v6, v6, v6 quad_perm:[1,0,3,2] row_mask:0xf bank_mask:0xf
    s_nop 1
    v_add_f32_dpp v6, v6, v6 quad_perm:[2,3,0,1] row_mask:0xf bank_mask:0xf
    s_nop 1
    v_add_f32_dpp v6, v6, v6 row_half_mirror row_mask:0xf bank_mask:0xf
    s_nop 1
    v_add_f32_dpp v6, v6, v6 row_mirror row_mask:0xf bank_mask:0xf
    s_nop 1
    v_add_f32_dpp v6, v6, v6 row_bcast:15 row_mask:0xa bank_mask:0xf
    s_nop 1
    v_add_f32_dpp v6, v6, v6 row_bcast:31 row_mask:0xc bank_mask:0xf
    s_nop 0
    v_readlane_b32 s37, v6, 63
    v_cvt_pk_bf16_f32 v11, v94, v95
    v_cvt_pk_bf16_f32 v12, v96, v97
    v_cvt_pk_bf16_f32 v13, v98, v99
    v_cvt_pk_bf16_f32 v14, v100, v101
    v_cvt_pk_bf16_f32 v15, v102, v103
    v_mov_b32 v8, 0x3acccccd
    v_mul_f32 v8, s37, v8
    v_cvt_pk_bf16_f32 v8, v8, v8
    v_and_b32 v8, 0xffff0000, v8
    v_add_f32 v8, 0x3727c5ac, v8
    v_cvt_pk_bf16_f32 v8, v8, v8
    v_and_b32 v8, 0xffff0000, v8
    v_sqrt_f32 v8, v8
    v_lshlrev_b32 v94, 16, v11
    v_and_b32 v95, 0xffff0000, v11
    v_lshlrev_b32 v96, 16, v12
    v_and_b32 v97, 0xffff0000, v12
    v_lshlrev_b32 v98, 16, v13
    v_and_b32 v99, 0xffff0000, v13
    v_lshlrev_b32 v100, 16, v14
    v_and_b32 v101, 0xffff0000, v14
    v_lshlrev_b32 v102, 16, v15
    v_and_b32 v103, 0xffff0000, v15
    v_cvt_pk_bf16_f32 v8, v8, v8
    v_and_b32 v8, 0xffff0000, v8
    v_rcp_f32 v9, v8
    v_rcp_f32 v8, v8
    s_nop 0
    v_pk_mul_f32 v[94:95], v[94:95], v[8:9]
    v_pk_mul_f32 v[96:97], v[96:97], v[8:9]
    v_pk_mul_f32 v[98:99], v[98:99], v[8:9]
    v_pk_mul_f32 v[100:101], v[100:101], v[8:9]
    v_pk_mul_f32 v[102:103], v[102:103], v[8:9]
    v_cvt_pk_bf16_f32 v11, v94, v95
    v_cvt_pk_bf16_f32 v12, v96, v97
    v_cvt_pk_bf16_f32 v13, v98, v99
    v_cvt_pk_bf16_f32 v14, v100, v101
    v_cvt_pk_bf16_f32 v15, v102, v103
    ds_write_b32 v85, v11 offset:0
    ds_write_b32 v85, v12 offset:256
    ds_write_b32 v85, v13 offset:544
    ds_write_b32 v85, v14 offset:800
    ds_write_b32 v85, v15 offset:1088
    s_waitcnt lgkmcnt(0)
    ds_read_b64_tr_b16 v[96:97], v86 offset:0
    ds_read_b64_tr_b16 v[98:99], v87 offset:0
    ds_read_b64_tr_b16 v[100:101], v86 offset:32
    ds_read_b64_tr_b16 v[102:103], v87 offset:32
    s_waitcnt lgkmcnt(2)
    v_mfma_f32_16x16x32_bf16 v[104:107], v[96:99], v[16:19], 0
    v_mfma_f32_16x16x32_bf16 v[112:115], v[96:99], v[20:23], 0
    s_waitcnt lgkmcnt(0)
    v_mfma_f32_16x16x32_bf16 v[108:111], v[100:103], v[16:19], 0
    v_mfma_f32_16x16x32_bf16 v[116:119], v[100:103], v[20:23], 0
    s_nop 3
    v_mul_f32 v6, v104, v24
    v_mul_f32 v7, v112, v24
    v_fmac_f32 v6, v112, v32
    v_fma_f32 v7, -v104, v32, v7
    v_cvt_pk_bf16_f32 v96, v6, v7
    v_mul_f32 v6, v105, v25
    v_mul_f32 v7, v113, v25
    v_fmac_f32 v6, v113, v33
    v_fma_f32 v7, -v105, v33, v7
    v_cvt_pk_bf16_f32 v97, v6, v7
    v_mul_f32 v6, v106, v26
    v_mul_f32 v7, v114, v26
    v_fmac_f32 v6, v114, v34
    v_fma_f32 v7, -v106, v34, v7
    v_cvt_pk_bf16_f32 v98, v6, v7
    v_mul_f32 v6, v107, v27
    v_mul_f32 v7, v115, v27
    v_fmac_f32 v6, v115, v35
    v_fma_f32 v7, -v107, v35, v7
    v_cvt_pk_bf16_f32 v99, v6, v7
    v_mul_f32 v6, v108, v28
    v_mul_f32 v7, v116, v28
    v_fmac_f32 v6, v116, v36
    v_fma_f32 v7, -v108, v36, v7
    v_cvt_pk_bf16_f32 v100, v6, v7
    v_mul_f32 v6, v109, v29
    v_mul_f32 v7, v117, v29
    v_fmac_f32 v6, v117, v37
    v_fma_f32 v7, -v109, v37, v7
    v_cvt_pk_bf16_f32 v101, v6, v7
    v_mul_f32 v6, v110, v30
    v_mul_f32 v7, v118, v30
    v_fmac_f32 v6, v118, v38
    v_fma_f32 v7, -v110, v38, v7
    v_cvt_pk_bf16_f32 v102, v6, v7
    v_mul_f32 v6, v111, v31
    v_mul_f32 v7, v119, v31
    v_fmac_f32 v6, v119, v39
    v_fma_f32 v7, -v111, v39, v7
    v_cvt_pk_bf16_f32 v103, v6, v7
    v_mfma_f32_16x16x32_bf16 v[104:107], v[40:43], v[96:99], 0
    v_mfma_f32_16x16x32_bf16 v[112:115], v[44:47], v[96:99], 0
    v_mfma_f32_16x16x32_bf16 v[108:111], v[56:59], v[96:99], 0
    v_mfma_f32_16x16x32_bf16 v[116:119], v[60:63], v[96:99], 0
    v_mfma_f32_16x16x32_bf16 v[104:107], v[48:51], v[100:103], v[104:107]
    v_mfma_f32_16x16x32_bf16 v[112:115], v[52:55], v[100:103], v[112:115]
    v_mfma_f32_16x16x32_bf16 v[108:111], v[64:67], v[100:103], v[108:111]
    v_mfma_f32_16x16x32_bf16 v[116:119], v[68:71], v[100:103], v[116:119]
    s_nop 5
    v_cvt_pk_bf16_f32 v96, v104, v112
    v_cvt_pk_bf16_f32 v97, v105, v113
    v_cvt_pk_bf16_f32 v98, v106, v114
    v_cvt_pk_bf16_f32 v99, v107, v115
    v_cvt_pk_bf16_f32 v100, v108, v116
    v_cvt_pk_bf16_f32 v101, v109, v117
    v_cvt_pk_bf16_f32 v102, v110, v118
    v_cvt_pk_bf16_f32 v103, v111, v119
    s_mov_b64 exec, s[26:27]
    ds_write_b32 v88, v96 offset:0
    ds_write_b32 v88, v97 offset:80
    ds_write_b32 v88, v98 offset:160
    ds_write_b32 v88, v99 offset:240
    s_mov_b64 exec, s[30:31]
    ds_write_b32 v89, v100 offset:240
    s_mov_b64 exec, s[28:29]
    ds_write_b32 v89, v101 offset:160
    ds_write_b32 v89, v102 offset:80
    ds_write_b32 v89, v103 offset:0
    s_mov_b64 exec, -1
    s_waitcnt lgkmcnt(0)
    s_barrier
    ds_read2st64_b32 v[96:97], v90 offset0:0 offset1:6
    ds_read2st64_b32 v[98:99], v90 offset0:12 offset1:18
    s_cmp_lt_u32 s3, 3
    s_cbranch_scc0 p1_one
    ds_read2st64_b32 v[100:101], v91 offset0:4 offset1:10
    ds_read2st64_b32 v[102:103], v91 offset0:16 offset1:22
    s_waitcnt lgkmcnt(2)
    v_mfma_f32_16x16x32_bf16 v[104:107], v[96:99], v[72:75], 0
    v_mfma_f32_16x16x32_bf16 v[112:115], v[96:99], v[76:79], 0
    s_nop 7
    v_cvt_pk_bf16_f32 v120, v104, v112
    v_cvt_pk_bf16_f32 v121, v105, v113
    v_cvt_pk_bf16_f32 v122, v106, v114
    v_cvt_pk_bf16_f32 v123, v107, v115
    buffer_store_dwordx4 v[120:123], v92, s[16:19], s34 offen
    s_waitcnt lgkmcnt(0)
    v_mfma_f32_16x16x32_bf16 v[108:111], v[100:103], v[72:75], 0
    v_mfma_f32_16x16x32_bf16 v[116:119], v[100:103], v[76:79], 0
    s_nop 7
    v_cvt_pk_bf16_f32 v124, v108, v116
    v_cvt_pk_bf16_f32 v125, v109, v117
    v_cvt_pk_bf16_f32 v126, v110, v118
    v_cvt_pk_bf16_f32 v127, v111, v119
    buffer_store_dwordx4 v[124:127], v92, s[16:19], s35 offen
    s_endpgm
p1_one:
    s_waitcnt lgkmcnt(0)
    v_mfma_f32_16x16x32_bf16 v[104:107], v[96:99], v[72:75], 0
    v_mfma_f32_16x16x32_bf16 v[112:115], v[96:99], v[76:79], 0
    s_nop 7
    v_cvt_pk_bf16_f32 v120, v104, v112
    v_cvt_pk_bf16_f32 v121, v105, v113
    v_cvt_pk_bf16_f32 v122, v106, v114
    v_cvt_pk_bf16_f32 v123, v107, v115
    buffer_store_dwordx4 v[120:123], v92, s[16:19], s34 offen
    s_endpgm
p1_rp:
    s_sub_u32 s2, s2, 256
    s_load_dwordx4 s[4:7], s[0:1], 32
    s_load_dwordx2 s[8:9], s[0:1], 72
    v_and_b32 v1, 63, v0
    v_lshrrev_b32 v2, 6, v0
    s_nop 0
    v_readfirstlane_b32 s3, v2
    s_lshr_b32 s10, s2, 3
    s_and_b32 s11, s2, 7
    s_mul_i32 s34, s10, 98304
    s_mul_i32 s35, s11, 384
    s_add_u32 s34, s34, s35
    s_and_b32 s35, s3, 3
    s_mul_i32 s35, s35, 24576
    s_add_u32 s34, s34, s35
    v_add_u32 v2, 0, v1
    v_mul_u32_u24 v3, 2731, v2
    v_lshrrev_b32 v3, 16, v3
    v_mul_u32_u24 v4, 24, v3
    v_sub_u32 v4, v2, v4
    v_lshlrev_b32 v4, 4, v4
    v_mul_u32_u24 v3, 3072, v3
    v_add_u32 v5, v3, v4
    v_add_u32 v2, 64, v1
    v_mul_u32_u24 v3, 2731, v2
    v_lshrrev_b32 v3, 16, v3
    v_mul_u32_u24 v4, 24, v3
    v_sub_u32 v4, v2, v4
    v_lshlrev_b32 v4, 4, v4
    v_mul_u32_u24 v3, 3072, v3
    v_add_u32 v6, v3, v4
    v_add_u32 v2, 128, v1
    v_mul_u32_u24 v3, 2731, v2
    v_lshrrev_b32 v3, 16, v3
    v_mul_u32_u24 v4, 24, v3
    v_sub_u32 v4, v2, v4
    v_lshlrev_b32 v4, 4, v4
    v_mul_u32_u24 v3, 3072, v3
    v_add_u32 v7, v3, v4
    s_mul_i32 s38, s3, 3072
    s_waitcnt lgkmcnt(0)
    s_cmp_ge_u32 s3, 4
    s_cselect_b32 s4, s6, s4
    s_cselect_b32 s5, s7, s5
    s_mov_b32 s12, s4
    s_mov_b32 s13, s5
    s_mov_b32 s14, 0x1e0000
    s_mov_b32 s15, 0x00020000
    s_mov_b32 m0, s38
    s_nop 0
    buffer_load_dwordx4 v5, s[12:15], s34 offen lds
    s_add_u32 s38, s38, 1024
    s_mov_b32 m0, s38
    s_nop 0
    buffer_load_dwordx4 v6, s[12:15], s34 offen lds
    s_add_u32 s38, s38, 1024
    s_mov_b32 m0, s38
    s_nop 0
    buffer_load_dwordx4 v7, s[12:15], s34 offen lds
    s_add_u32 s16, s8, 0xc00000
    s_addc_u32 s17, s9, 0
    s_mov_b32 s18, 0x3c0000
    s_mov_b32 s19, 0x00020000
    v_lshrrev_b32 v12, 4, v1
    v_and_b32 v10, 15, v1
    v_and_b32 v11, 3, v10
    v_lshrrev_b32 v10, 2, v10
    v_lshl_add_u32 v2, v12, 3, v10
    v_mul_u32_u24 v2, 384, v2
    v_lshl_add_u32 v8, v11, 3, v2
    v_lshlrev_b32 v9, 4, v1
    s_mul_i32 s35, s3, 3
    s_add_u32 s35, s35, 0
    s_cmp_ge_u32 s35, 12
    s_cselect_b32 s36, 1, 0
    s_mul_i32 s37, s36, 12
    s_sub_u32 s37, s35, s37
    s_and_b32 s39, s37, 1
    s_mul_i32 s39, s39, 12288
    s_lshr_b32 s33, s37, 1
    s_lshl_b32 s33, s33, 5
    s_add_u32 s39, s39, s33
    s_mul_i32 s33, s36, 192
    s_add_u32 s40, s39, s33
    s_lshl_b32 s33, s11, 1
    s_add_u32 s33, s33, s36
    s_mul_i32 s33, s33, 20
    s_add_u32 s33, s33, s10
    s_mul_i32 s33, s33, 12
    s_add_u32 s33, s33, s37
    s_lshl_b32 s44, s33, 10
    s_mul_i32 s35, s3, 3
    s_add_u32 s35, s35, 1
    s_cmp_ge_u32 s35, 12
    s_cselect_b32 s36, 1, 0
    s_mul_i32 s37, s36, 12
    s_sub_u32 s37, s35, s37
    s_and_b32 s39, s37, 1
    s_mul_i32 s39, s39, 12288
    s_lshr_b32 s33, s37, 1
    s_lshl_b32 s33, s33, 5
    s_add_u32 s39, s39, s33
    s_mul_i32 s33, s36, 192
    s_add_u32 s41, s39, s33
    s_lshl_b32 s33, s11, 1
    s_add_u32 s33, s33, s36
    s_mul_i32 s33, s33, 20
    s_add_u32 s33, s33, s10
    s_mul_i32 s33, s33, 12
    s_add_u32 s33, s33, s37
    s_lshl_b32 s45, s33, 10
    s_mul_i32 s35, s3, 3
    s_add_u32 s35, s35, 2
    s_cmp_ge_u32 s35, 12
    s_cselect_b32 s36, 1, 0
    s_mul_i32 s37, s36, 12
    s_sub_u32 s37, s35, s37
    s_and_b32 s39, s37, 1
    s_mul_i32 s39, s39, 12288
    s_lshr_b32 s33, s37, 1
    s_lshl_b32 s33, s33, 5
    s_add_u32 s39, s39, s33
    s_mul_i32 s33, s36, 192
    s_add_u32 s42, s39, s33
    s_lshl_b32 s33, s11, 1
    s_add_u32 s33, s33, s36
    s_mul_i32 s33, s33, 20
    s_add_u32 s33, s33, s10
    s_mul_i32 s33, s33, 12
    s_add_u32 s33, s33, s37
    s_lshl_b32 s46, s33, 10
    v_add_u32 v13, s40, v8
    v_add_u32 v14, s41, v8
    v_add_u32 v15, s42, v8
    s_waitcnt vmcnt(0)
    s_barrier
    ds_read_b64_tr_b16 v[16:17], v13
    ds_read_b64_tr_b16 v[18:19], v13 offset:1536
    ds_read_b64_tr_b16 v[20:21], v14
    ds_read_b64_tr_b16 v[22:23], v14 offset:1536
    ds_read_b64_tr_b16 v[24:25], v15
    ds_read_b64_tr_b16 v[26:27], v15 offset:1536
    s_waitcnt lgkmcnt(4)
    buffer_store_dwordx4 v[16:19], v9, s[16:19], s44 offen sc1
    s_waitcnt lgkmcnt(2)
    buffer_store_dwordx4 v[20:23], v9, s[16:19], s45 offen sc1
    s_waitcnt lgkmcnt(0)
    buffer_store_dwordx4 v[24:27], v9, s[16:19], s46 offen sc1
rp_w13_done:
    s_endpgm
p1_kernel_end:
    s_endpgm
.globl p2_kernel
.p2align 8
.type p2_kernel,@function
p2_kernel:
    s_cmp_ge_u32 s2, 264
    s_cbranch_scc1 p2_kernel_end
    s_cmp_ge_u32 s2, 168
    s_cbranch_scc1 p2_rp
    s_load_dwordx4 s[4:7], s[0:1], 8
    s_load_dwordx2 s[8:9], s[0:1], 72
    s_cmp_lt_u32 s2, 16
    s_cbranch_scc0 p2_kernel_pf_skip
    s_getpc_b64 s[60:61]
p2_kernel_pf:
    s_add_u32 s60, s60, p3_kernel-p2_kernel_pf
    s_addc_u32 s61, s61, 0
    v_lshlrev_b32 v8, 7, v0
    v_min_u32 v8, p3_kernel_end-p3_kernel, v8
    v_mov_b32 v9, s61
    v_add_co_u32 v8, vcc, s60, v8
    s_nop 1
    v_addc_co_u32 v9, vcc, 0, v9, vcc
    global_load_dword v10, v[8:9], off
p2_kernel_pf_skip:
    v_and_b32 v1, 63, v0
    v_lshrrev_b32 v4, 6, v0
    s_nop 0
    v_readfirstlane_b32 s3, v4
    v_lshrrev_b32 v2, 4, v1
    v_and_b32 v3, 15, v0
    s_and_b32 s10, s2, 7
    s_lshr_b32 s11, s2, 3
    v_and_b32 v4, 3, v1
    v_xor_b32 v4, v4, v2
    v_lshlrev_b32 v4, 4, v4
    v_lshrrev_b32 v5, 2, v1
    v_lshl_add_u32 v7, v5, 7, v4
    s_lshr_b32 s34, s11, 1
    s_mul_i32 s35, s10, 11
    s_add_u32 s34, s34, s35
    s_lshl_b32 s34, s34, 15
    s_and_b32 s35, s11, 1
    s_lshl_b32 s35, s35, 6
    s_add_u32 s34, s34, s35
    s_lshl_b32 s35, s3, 12
    s_add_u32 s34, s34, s35
    s_add_u32 s35, s34, 2048
    s_lshl_b32 s36, s11, 4
    s_min_u32 s36, s36, 305
    s_mul_i32 s37, s10, 321
    s_add_u32 s36, s36, s37
    s_mul_i32 s37, s3, 82176
    s_add_u32 s36, s36, s37
    s_lshl_b32 s36, s36, 1
    v_lshrrev_b32 v4, 1, v1
    v_mov_b32 v5, 5136
    v_mul_u32_u24 v11, v4, v5
    v_and_b32 v5, 1, v1
    v_lshl_add_u32 v11, v5, 4, v11
    s_lshl_b32 s38, s3, 11
    s_mov_b32 m0, s38
    s_waitcnt lgkmcnt(0)
    s_mov_b32 s12, s8
    s_mov_b32 s13, s9
    s_mov_b32 s14, 0x2c0000
    s_mov_b32 s15, 0x00020000
    buffer_load_dwordx4 v7, s[12:15], s34 offen lds
    s_add_u32 s38, s38, 1024
    s_mov_b32 m0, s38
    s_mov_b32 s16, s4
    s_mov_b32 s17, s5
    s_mov_b32 s18, 0x141000
    s_mov_b32 s19, 0x00020000
    buffer_load_dwordx4 v7, s[12:15], s35 offen lds
    s_mov_b32 s20, s6
    s_mov_b32 s21, s7
    s_mov_b32 s22, 0x141000
    s_mov_b32 s23, 0x00020000
    buffer_load_dwordx4 v[12:15], v11, s[16:19], s36 offen
    buffer_load_dwordx4 v[16:19], v11, s[20:23], s36 offen
    s_add_u32 s24, s8, 0x300000
    s_addc_u32 s25, s9, 0
    s_mov_b32 s26, 0x2c0000
    s_mov_b32 s27, 0x00020000
    v_cvt_f32_u32 v20, v2
    v_cvt_f32_u32 v21, v3
    v_mul_f32 v6, 4.0, v20
    v_mul_f32 v22, 0x3d800000, v21
    v_mul_f32 v21, 0x3b800000, v21
    v_add_f32 v4, 0x00000000, v6
    v_mul_f32 v5, v4, v22
    v_mul_f32 v4, v4, v21
    v_cos_f32 v23, v5
    v_sin_f32 v24, v5
    v_cos_f32 v36, v4
    v_sin_f32 v40, v4
    v_cvt_pk_bf16_f32 v28, v23, v24
    v_cvt_pk_bf16_f32 v32, -v24, v23
    v_add_f32 v4, 0x3f800000, v6
    v_mul_f32 v5, v4, v22
    v_mul_f32 v4, v4, v21
    v_cos_f32 v23, v5
    v_sin_f32 v24, v5
    v_cos_f32 v37, v4
    v_sin_f32 v41, v4
    v_cvt_pk_bf16_f32 v29, v23, v24
    v_cvt_pk_bf16_f32 v33, -v24, v23
    v_add_f32 v4, 0x40000000, v6
    v_mul_f32 v5, v4, v22
    v_mul_f32 v4, v4, v21
    v_cos_f32 v23, v5
    v_sin_f32 v24, v5
    v_cos_f32 v38, v4
    v_sin_f32 v42, v4
    v_cvt_pk_bf16_f32 v30, v23, v24
    v_cvt_pk_bf16_f32 v34, -v24, v23
    v_add_f32 v4, 0x40400000, v6
    v_mul_f32 v5, v4, v22
    v_mul_f32 v4, v4, v21
    v_cos_f32 v23, v5
    v_sin_f32 v24, v5
    v_cos_f32 v39, v4
    v_sin_f32 v43, v4
    v_cvt_pk_bf16_f32 v31, v23, v24
    v_cvt_pk_bf16_f32 v35, -v24, v23
    v_lshrrev_b32 v4, 2, v3
    s_lshr_b32 s39, s3, 1
    v_xor_b32 v4, s39, v4
    v_lshlrev_b32 v4, 4, v4
    v_lshl_add_u32 v4, v3, 6, v4
    v_lshl_add_u32 v4, v2, 12, v4
    s_and_b32 s39, s3, 1
    s_lshl_b32 s39, s39, 3
    v_add_u32 v25, s39, v4
    s_lshr_b32 s39, s3, 1
    s_lshl_b32 s39, s39, 4
    s_lshl_b32 s40, s3, 5
    s_add_u32 s39, s39, s40
    s_lshl_b32 s39, s39, 3
    s_add_u32 s39, s39, 16384
    v_lshrrev_b32 v4, 1, v1
    v_lshlrev_b32 v4, 3, v4
    v_and_b32 v5, 1, v1
    v_mov_b32 v6, 10240
    v_mad_u32_u24 v4, v5, v6, v4
    v_add_u32 v26, s39, v4
    s_cmp_eq_u32 s11, 20
    s_cselect_b32 s39, 7, s3
    s_mov_b32 s41, 0x01000c0c
    s_cselect_b32 s41, 0x03020c0c, s41
    s_mul_i32 s39, s39, 2560
    s_add_u32 s39, s39, 16384
    v_mov_b32 v6, 80
    v_mad_u32_u24 v4, v2, v6, v3
    v_lshlrev_b32 v4, 3, v4
    v_add_u32 v27, s39, v4
    s_lshl_b32 s39, s3, 11
    v_lshlrev_b32 v4, 4, v1
    v_add_u32 v44, s39, v4
    s_waitcnt vmcnt(1)
    ds_write_b32 v26, v12 offset:0
    ds_write_b32 v26, v13 offset:2560
    ds_write_b32 v26, v14 offset:5120
    ds_write_b32 v26, v15 offset:7680
    s_waitcnt vmcnt(0)
    ds_write_b32 v26, v16 offset:4
    ds_write_b32 v26, v17 offset:2564
    ds_write_b32 v26, v18 offset:5124
    ds_write_b32 v26, v19 offset:7684
    s_waitcnt lgkmcnt(0)
    s_barrier
    ds_read_b64 v[48:49], v25 offset:0
    ds_read_b64 v[50:51], v25 offset:1024
    ds_read_b64 v[52:53], v25 offset:2048
    ds_read_b64 v[54:55], v25 offset:3072
    ds_read_b64 v[56:57], v27 offset:0
    ds_read_b64 v[58:59], v27 offset:128
    ds_read_b64 v[60:61], v27 offset:256
    ds_read_b64 v[62:63], v27 offset:384
    s_waitcnt lgkmcnt(4)
    v_mov_b32 v20, v48
    v_mov_b32 v64, v49
    v_mov_b32 v21, v50
    v_mov_b32 v65, v51
    v_mov_b32 v22, v52
    v_mov_b32 v66, v53
    v_mov_b32 v23, v54
    v_mov_b32 v67, v55
    s_nop 0
    v_mfma_f32_16x16x32_bf16 v[68:71], v[20:23], v[28:31], 0
    v_mfma_f32_16x16x32_bf16 v[76:79], v[20:23], v[32:35], 0
    v_mfma_f32_16x16x32_bf16 v[72:75], v[64:67], v[28:31], 0
    v_mfma_f32_16x16x32_bf16 v[80:83], v[64:67], v[32:35], 0
    s_nop 4
    v_mul_f32 v24, v68, v36
    v_mul_f32 v45, v76, v36
    v_fmac_f32 v24, v76, v40
    v_fma_f32 v45, -v68, v40, v45
    v_cvt_pk_bf16_f32 v20, v24, v45
    v_mul_f32 v46, v69, v37
    v_mul_f32 v47, v77, v37
    v_fmac_f32 v46, v77, v41
    v_fma_f32 v47, -v69, v41, v47
    v_cvt_pk_bf16_f32 v21, v46, v47
    v_mul_f32 v24, v70, v38
    v_mul_f32 v45, v78, v38
    v_fmac_f32 v24, v78, v42
    v_fma_f32 v45, -v70, v42, v45
    v_cvt_pk_bf16_f32 v22, v24, v45
    v_mul_f32 v46, v71, v39
    v_mul_f32 v47, v79, v39
    v_fmac_f32 v46, v79, v43
    v_fma_f32 v47, -v71, v43, v47
    v_cvt_pk_bf16_f32 v23, v46, v47
    v_mul_f32 v24, v72, v36
    v_mul_f32 v45, v80, v36
    v_fmac_f32 v24, v80, v40
    v_fma_f32 v45, -v72, v40, v45
    v_cvt_pk_bf16_f32 v64, v24, v45
    v_mul_f32 v46, v73, v37
    v_mul_f32 v47, v81, v37
    v_fmac_f32 v46, v81, v41
    v_fma_f32 v47, -v73, v41, v47
    v_cvt_pk_bf16_f32 v65, v46, v47
    v_mul_f32 v24, v74, v38
    v_mul_f32 v45, v82, v38
    v_fmac_f32 v24, v82, v42
    v_fma_f32 v45, -v74, v42, v45
    v_cvt_pk_bf16_f32 v66, v24, v45
    v_mul_f32 v46, v75, v39
    v_mul_f32 v47, v83, v39
    v_fmac_f32 v46, v83, v43
    v_fma_f32 v47, -v75, v43, v47
    v_cvt_pk_bf16_f32 v67, v46, v47
    v_mfma_f32_16x16x32_bf16 v[68:71], v[28:31], v[20:23], 0
    v_mfma_f32_16x16x32_bf16 v[76:79], v[32:35], v[20:23], 0
    v_mfma_f32_16x16x32_bf16 v[72:75], v[28:31], v[64:67], 0
    v_mfma_f32_16x16x32_bf16 v[80:83], v[32:35], v[64:67], 0
    s_waitcnt lgkmcnt(0)
    v_perm_b32 v84, v56, v56, s41
    v_perm_b32 v92, v57, v57, s41
    v_and_b32 v88, 0xffff0000, v56
    v_and_b32 v96, 0xffff0000, v57
    v_perm_b32 v85, v58, v58, s41
    v_perm_b32 v93, v59, v59, s41
    v_and_b32 v89, 0xffff0000, v58
    v_and_b32 v97, 0xffff0000, v59
    v_perm_b32 v86, v60, v60, s41
    v_perm_b32 v94, v61, v61, s41
    v_and_b32 v90, 0xffff0000, v60
    v_and_b32 v98, 0xffff0000, v61
    v_perm_b32 v87, v62, v62, s41
    v_perm_b32 v95, v63, v63, s41
    v_and_b32 v91, 0xffff0000, v62
    v_and_b32 v99, 0xffff0000, v63
    v_mul_f32 v24, v68, v84
    v_mul_f32 v45, v68, v92
    v_fma_f32 v24, -v76, v92, v24
    v_fmac_f32 v45, v76, v84
    v_cvt_pk_bf16_f32 v20, v45, v24
    v_mul_f32 v46, v69, v85
    v_mul_f32 v47, v69, v93
    v_fma_f32 v46, -v77, v93, v46
    v_fmac_f32 v47, v77, v85
    v_cvt_pk_bf16_f32 v21, v47, v46
    v_mul_f32 v24, v70, v86
    v_mul_f32 v45, v70, v94
    v_fma_f32 v24, -v78, v94, v24
    v_fmac_f32 v45, v78, v86
    v_cvt_pk_bf16_f32 v22, v45, v24
    v_mul_f32 v46, v71, v87
    v_mul_f32 v47, v71, v95
    v_fma_f32 v46, -v79, v95, v46
    v_fmac_f32 v47, v79, v87
    v_cvt_pk_bf16_f32 v23, v47, v46
    v_mul_f32 v24, v72, v88
    v_mul_f32 v45, v72, v96
    v_fma_f32 v24, -v80, v96, v24
    v_fmac_f32 v45, v80, v88
    v_cvt_pk_bf16_f32 v64, v45, v24
    v_mul_f32 v46, v73, v89
    v_mul_f32 v47, v73, v97
    v_fma_f32 v46, -v81, v97, v46
    v_fmac_f32 v47, v81, v89
    v_cvt_pk_bf16_f32 v65, v47, v46
    v_mul_f32 v24, v74, v90
    v_mul_f32 v45, v74, v98
    v_fma_f32 v24, -v82, v98, v24
    v_fmac_f32 v45, v82, v90
    v_cvt_pk_bf16_f32 v66, v45, v24
    v_mul_f32 v46, v75, v91
    v_mul_f32 v47, v75, v99
    v_fma_f32 v46, -v83, v99, v46
    v_fmac_f32 v47, v83, v91
    v_cvt_pk_bf16_f32 v67, v47, v46
    v_mfma_f32_16x16x32_bf16 v[68:71], v[20:23], v[28:31], 0
    v_mfma_f32_16x16x32_bf16 v[76:79], v[20:23], v[32:35], 0
    v_mfma_f32_16x16x32_bf16 v[72:75], v[64:67], v[28:31], 0
    v_mfma_f32_16x16x32_bf16 v[80:83], v[64:67], v[32:35], 0
    s_nop 4
    v_mul_f32 v24, v68, v36
    v_mul_f32 v45, v76, v36
    v_fmac_f32 v24, v76, v40
    v_fma_f32 v45, -v68, v40, v45
    v_cvt_pk_bf16_f32 v20, v24, v45
    v_mul_f32 v46, v69, v37
    v_mul_f32 v47, v77, v37
    v_fmac_f32 v46, v77, v41
    v_fma_f32 v47, -v69, v41, v47
    v_cvt_pk_bf16_f32 v21, v46, v47
    v_mul_f32 v24, v70, v38
    v_mul_f32 v45, v78, v38
    v_fmac_f32 v24, v78, v42
    v_fma_f32 v45, -v70, v42, v45
    v_cvt_pk_bf16_f32 v22, v24, v45
    v_mul_f32 v46, v71, v39
    v_mul_f32 v47, v79, v39
    v_fmac_f32 v46, v79, v43
    v_fma_f32 v47, -v71, v43, v47
    v_cvt_pk_bf16_f32 v23, v46, v47
    v_mul_f32 v24, v72, v36
    v_mul_f32 v45, v80, v36
    v_fmac_f32 v24, v80, v40
    v_fma_f32 v45, -v72, v40, v45
    v_cvt_pk_bf16_f32 v64, v24, v45
    v_mul_f32 v46, v73, v37
    v_mul_f32 v47, v81, v37
    v_fmac_f32 v46, v81, v41
    v_fma_f32 v47, -v73, v41, v47
    v_cvt_pk_bf16_f32 v65, v46, v47
    v_mul_f32 v24, v74, v38
    v_mul_f32 v45, v82, v38
    v_fmac_f32 v24, v82, v42
    v_fma_f32 v45, -v74, v42, v45
    v_cvt_pk_bf16_f32 v66, v24, v45
    v_mul_f32 v46, v75, v39
    v_mul_f32 v47, v83, v39
    v_fmac_f32 v46, v83, v43
    v_fma_f32 v47, -v75, v43, v47
    v_cvt_pk_bf16_f32 v67, v46, v47
    v_mfma_f32_16x16x32_bf16 v[68:71], v[28:31], v[20:23], 0
    v_mfma_f32_16x16x32_bf16 v[76:79], v[32:35], v[20:23], 0
    v_mfma_f32_16x16x32_bf16 v[72:75], v[28:31], v[64:67], 0
    v_mfma_f32_16x16x32_bf16 v[80:83], v[32:35], v[64:67], 0
    s_nop 5
    v_cvt_pk_bf16_f32 v48, v76, v68
    v_cvt_pk_bf16_f32 v50, v77, v69
    v_cvt_pk_bf16_f32 v52, v78, v70
    v_cvt_pk_bf16_f32 v54, v79, v71
    v_cvt_pk_bf16_f32 v49, v80, v72
    v_cvt_pk_bf16_f32 v51, v81, v73
    v_cvt_pk_bf16_f32 v53, v82, v74
    v_cvt_pk_bf16_f32 v55, v83, v75
    ds_write_b64 v25, v[48:49] offset:0
    ds_write_b64 v25, v[50:51] offset:1024
    ds_write_b64 v25, v[52:53] offset:2048
    ds_write_b64 v25, v[54:55] offset:3072
    s_waitcnt lgkmcnt(0)
    s_barrier
    ds_read_b128 v[20:23], v44
    ds_read_b128 v[64:67], v44 offset:1024
    s_waitcnt lgkmcnt(1)
    buffer_store_dwordx4 v[20:23], v7, s[24:27], s34 offen
    s_waitcnt lgkmcnt(0)
    buffer_store_dwordx4 v[64:67], v7, s[24:27], s35 offen
    s_endpgm
p2_rp:
    s_sub_u32 s2, s2, 168
    s_load_dwordx2 s[4:5], s[0:1], 48
    s_load_dwordx2 s[8:9], s[0:1], 72
    v_and_b32 v1, 63, v0
    v_lshrrev_b32 v2, 6, v0
    s_nop 0
    v_readfirstlane_b32 s3, v2
    s_lshr_b32 s10, s2, 1
    s_and_b32 s11, s2, 1
    s_mul_i32 s34, s10, 40960
    s_mul_i32 s35, s11, 640
    s_add_u32 s34, s34, s35
    s_mul_i32 s35, s3, 192
    s_add_u32 s35, s35, 0
    v_add_u32 v2, s35, v1
    v_mul_u32_u24 v3, 1639, v2
    v_lshrrev_b32 v3, 16, v3
    v_mul_u32_u24 v4, 40, v3
    v_sub_u32 v4, v2, v4
    v_lshlrev_b32 v4, 4, v4
    v_mul_u32_u24 v3, 1280, v3
    v_add_u32 v5, v3, v4
    v_mov_b32 v3, 0x40000000
    v_cmp_gt_u32 vcc, 1280, v2
    s_nop 1
    v_cndmask_b32 v5, v3, v5, vcc
    s_mul_i32 s35, s3, 192
    s_add_u32 s35, s35, 64
    v_add_u32 v2, s35, v1
    v_mul_u32_u24 v3, 1639, v2
    v_lshrrev_b32 v3, 16, v3
    v_mul_u32_u24 v4, 40, v3
    v_sub_u32 v4, v2, v4
    v_lshlrev_b32 v4, 4, v4
    v_mul_u32_u24 v3, 1280, v3
    v_add_u32 v6, v3, v4
    v_mov_b32 v3, 0x40000000
    v_cmp_gt_u32 vcc, 1280, v2
    s_nop 1
    v_cndmask_b32 v6, v3, v6, vcc
    s_mul_i32 s35, s3, 192
    s_add_u32 s35, s35, 128
    v_add_u32 v2, s35, v1
    v_mul_u32_u24 v3, 1639, v2
    v_lshrrev_b32 v3, 16, v3
    v_mul_u32_u24 v4, 40, v3
    v_sub_u32 v4, v2, v4
    v_lshlrev_b32 v4, 4, v4
    v_mul_u32_u24 v3, 1280, v3
    v_add_u32 v7, v3, v4
    v_mov_b32 v3, 0x40000000
    v_cmp_gt_u32 vcc, 1280, v2
    s_nop 1
    v_cndmask_b32 v7, v3, v7, vcc
    s_mul_i32 s38, s3, 3072
    s_waitcnt lgkmcnt(0)
    s_mov_b32 s12, s4
    s_mov_b32 s13, s5
    s_mov_b32 s14, 0x1e0000
    s_mov_b32 s15, 0x00020000
    s_mov_b32 m0, s38
    s_nop 0
    buffer_load_dwordx4 v5, s[12:15], s34 offen lds
    s_add_u32 s38, s38, 1024
    s_mov_b32 m0, s38
    s_nop 0
    buffer_load_dwordx4 v6, s[12:15], s34 offen lds
    s_add_u32 s38, s38, 1024
    s_mov_b32 m0, s38
    s_nop 0
    buffer_load_dwordx4 v7, s[12:15], s34 offen lds
    s_add_u32 s16, s8, 0x1000000
    s_addc_u32 s17, s9, 0
    s_mov_b32 s18, 0x1e0000
    s_mov_b32 s19, 0x00020000
    v_lshrrev_b32 v12, 4, v1
    v_and_b32 v10, 15, v1
    v_and_b32 v11, 3, v10
    v_lshrrev_b32 v10, 2, v10
    v_lshl_add_u32 v2, v12, 2, v10
    v_mul_u32_u24 v2, 640, v2
    v_mul_u32_u24 v3, 40, v11
    v_add_u32 v8, v2, v3
    v_lshlrev_b32 v9, 4, v1
    s_mul_i32 s35, s3, 3
    s_add_u32 s35, s35, 0
    s_mul_i32 s36, s35, 13108
    s_lshr_b32 s36, s36, 16
    s_mul_i32 s37, s36, 5
    s_sub_u32 s37, s35, s37
    s_mul_i32 s39, s36, 160
    s_lshl_b32 s33, s37, 3
    s_add_u32 s40, s39, s33
    s_lshl_b32 s33, s11, 2
    s_add_u32 s33, s33, s36
    s_mul_i32 s33, s33, 48
    s_add_u32 s33, s33, s10
    s_mul_i32 s33, s33, 5
    s_add_u32 s33, s33, s37
    s_lshl_b32 s33, s33, 10
    s_cmp_lt_u32 s35, 20
    s_cselect_b32 s44, s33, 0x40000000
    s_cselect_b32 s40, s40, 0
    s_mul_i32 s35, s3, 3
    s_add_u32 s35, s35, 1
    s_mul_i32 s36, s35, 13108
    s_lshr_b32 s36, s36, 16
    s_mul_i32 s37, s36, 5
    s_sub_u32 s37, s35, s37
    s_mul_i32 s39, s36, 160
    s_lshl_b32 s33, s37, 3
    s_add_u32 s41, s39, s33
    s_lshl_b32 s33, s11, 2
    s_add_u32 s33, s33, s36
    s_mul_i32 s33, s33, 48
    s_add_u32 s33, s33, s10
    s_mul_i32 s33, s33, 5
    s_add_u32 s33, s33, s37
    s_lshl_b32 s33, s33, 10
    s_cmp_lt_u32 s35, 20
    s_cselect_b32 s45, s33, 0x40000000
    s_cselect_b32 s41, s41, 0
    s_mul_i32 s35, s3, 3
    s_add_u32 s35, s35, 2
    s_mul_i32 s36, s35, 13108
    s_lshr_b32 s36, s36, 16
    s_mul_i32 s37, s36, 5
    s_sub_u32 s37, s35, s37
    s_mul_i32 s39, s36, 160
    s_lshl_b32 s33, s37, 3
    s_add_u32 s42, s39, s33
    s_lshl_b32 s33, s11, 2
    s_add_u32 s33, s33, s36
    s_mul_i32 s33, s33, 48
    s_add_u32 s33, s33, s10
    s_mul_i32 s33, s33, 5
    s_add_u32 s33, s33, s37
    s_lshl_b32 s33, s33, 10
    s_cmp_lt_u32 s35, 20
    s_cselect_b32 s46, s33, 0x40000000
    s_cselect_b32 s42, s42, 0
    v_add_u32 v13, s40, v8
    v_add_u32 v14, s41, v8
    v_add_u32 v15, s42, v8
    s_waitcnt vmcnt(0)
    s_barrier
    ds_read_b64_tr_b16 v[16:17], v13
    ds_read_b64_tr_b16 v[18:19], v13 offset:10240
    ds_read_b64_tr_b16 v[20:21], v14
    ds_read_b64_tr_b16 v[22:23], v14 offset:10240
    ds_read_b64_tr_b16 v[24:25], v15
    ds_read_b64_tr_b16 v[26:27], v15 offset:10240
    s_waitcnt lgkmcnt(4)
    s_cmp_eq_u32 s44, 0x40000000
    s_cbranch_scc1 rp_w2_done
    buffer_store_dwordx4 v[16:19], v9, s[16:19], s44 offen sc1
    s_waitcnt lgkmcnt(2)
    s_cmp_eq_u32 s45, 0x40000000
    s_cbranch_scc1 rp_w2_done
    buffer_store_dwordx4 v[20:23], v9, s[16:19], s45 offen sc1
    s_waitcnt lgkmcnt(0)
    s_cmp_eq_u32 s46, 0x40000000
    s_cbranch_scc1 rp_w2_done
    buffer_store_dwordx4 v[24:27], v9, s[16:19], s46 offen sc1
rp_w2_done:
    s_endpgm
p2_kernel_end:
    s_endpgm
.globl p3_kernel
.p2align 8
.type p3_kernel,@function
p3_kernel:
    s_cmp_ge_u32 s2, 256
    s_cbranch_scc1 p3_kernel_end
    s_load_dwordx2 s[4:5], s[0:1], 0
    s_load_dwordx2 s[6:7], s[0:1], 72
    s_cmp_lt_u32 s2, 16
    s_cbranch_scc0 p3_kernel_pf_skip
    s_getpc_b64 s[60:61]
p3_kernel_pf:
    s_add_u32 s60, s60, p4_kernel-p3_kernel_pf
    s_addc_u32 s61, s61, 0
    v_lshlrev_b32 v8, 7, v0
    v_min_u32 v8, p4_kernel_end-p4_kernel, v8
    v_mov_b32 v9, s61
    v_add_co_u32 v8, vcc, s60, v8
    s_nop 1
    v_addc_co_u32 v9, vcc, 0, v9, vcc
    global_load_dword v10, v[8:9], off
p3_kernel_pf_skip:
    v_and_b32 v1, 63, v0
    v_lshrrev_b32 v4, 6, v0
    s_nop 0
    v_readfirstlane_b32 s3, v4
    v_lshrrev_b32 v2, 4, v1
    v_and_b32 v3, 15, v0
    s_getpc_b64 s[52:53]
    s_add_u32 s52, s52, p3_tab@rel32@lo+4
    s_addc_u32 s53, s53, p3_tab@rel32@hi+12
    v_lshlrev_b32 v4, 4, v1
    s_lshl_b32 s54, s3, 10
    v_add_u32 v5, s54, v4
    v_add_u32 v5, 2048, v5
    v_mov_b32 v15, s53
    v_add_co_u32 v14, vcc, s52, v5
    s_nop 1
    v_addc_co_u32 v15, vcc, 0, v15, vcc
    s_add_u32 s54, s54, 28048
    s_mov_b32 m0, s54
    s_nop 0
    global_load_lds_dwordx4 v[14:15], off
    s_cmp_lt_u32 s3, 7
    s_cbranch_scc0 p3_skip1
    v_add_co_u32 v14, vcc, 0x2000, v14
    s_nop 1
    v_addc_co_u32 v15, vcc, 0, v15, vcc
    s_add_u32 m0, s54, 8192
    s_nop 0
    global_load_lds_dwordx4 v[14:15], off
p3_skip1:
    v_lshrrev_b32 v4, 3, v3
    v_lshl_add_u32 v4, v4, 2, v2
    s_lshl_b32 s54, s3, 3
    v_add_u32 v4, s54, v4
    v_lshlrev_b32 v5, 4, v4
    v_mov_b32 v13, s53
    v_add_co_u32 v12, vcc, s52, v5
    s_nop 1
    v_addc_co_u32 v13, vcc, 0, v13, vcc
    global_load_dwordx3 v[24:26], v[12:13], off
    s_cmp_lt_u32 s3, 3
    s_cbranch_scc0 p3_skip0
    global_load_dwordx3 v[28:30], v[12:13], off offset:1024
p3_skip0:
    v_lshrrev_b32 v4, 1, v2
    s_mov_b32 s10, 1441792
    v_mul_lo_u32 v4, v4, s10
    v_lshl_add_u32 v27, v3, 2, v4
    v_and_b32 v5, 1, v2
    v_lshl_add_u32 v11, v5, 6, v27
    s_cmp_eq_u32 s3, 2
    s_cselect_b64 s[32:33], -1, 0
    v_cndmask_b32 v27, v11, v27, s[32:33]
    s_lshl_b32 s34, s3, 15
    s_lshl_b32 s35, s2, 7
    s_add_u32 s34, s34, s35
    s_add_u32 s35, s34, 262144
    s_lshl_b32 s8, s3, 8
    s_add_u32 s8, s8, s2
    s_mul_i32 s8, s8, 1280
    v_lshlrev_b32 v4, 4, v2
    v_lshl_add_u32 v31, v3, 6, v4
    v_and_b32 v5, 3, v3
    v_lshl_add_u32 v4, v5, 6, v4
    v_lshrrev_b32 v5, 2, v3
    v_lshl_add_u32 v4, v5, 3, v4
    v_add_u32 v4, 1024, v4
    v_cmp_gt_u32 s[50:51], 8, v3
    v_mov_b32 v5, 0x40000000
    s_nop 0
    v_cndmask_b32 v32, v5, v4, s[50:51]
    s_waitcnt lgkmcnt(0)
    s_add_u32 s12, s6, 0x300000
    s_addc_u32 s13, s7, 0
    s_mov_b32 s14, 0x2c0000
    s_mov_b32 s15, 0x00020000
    s_add_u32 s36, s34, 0
    buffer_load_dword v36, v11, s[12:15], s36 offen
    s_add_u32 s36, s34, 360448
    buffer_load_dword v37, v11, s[12:15], s36 offen
    s_add_u32 s36, s34, 720896
    buffer_load_dword v38, v11, s[12:15], s36 offen
    s_add_u32 s36, s34, 1081344
    buffer_load_dword v39, v11, s[12:15], s36 offen
    s_cmp_lt_u32 s3, 3
    s_cbranch_scc0 p3_skip2
    s_add_u32 s36, s35, 0
    buffer_load_dword v40, v27, s[12:15], s36 offen
    s_add_u32 s36, s35, 360448
    buffer_load_dword v41, v27, s[12:15], s36 offen
    s_add_u32 s36, s35, 720896
    buffer_load_dword v42, v27, s[12:15], s36 offen
    s_add_u32 s36, s35, 1081344
    buffer_load_dword v43, v27, s[12:15], s36 offen
p3_skip2:
    s_mov_b32 s16, s4
    s_mov_b32 s17, s5
    s_mov_b32 s18, 0x280000
    s_mov_b32 s19, 0x00020000
    buffer_load_dwordx4 v[44:47], v31, s[16:19], s8 offen
    buffer_load_dwordx2 v[48:49], v32, s[16:19], s8 offen
    s_add_u32 s20, s6, 0x600000
    s_addc_u32 s21, s7, 0
    s_mov_b32 s22, 0x280000
    s_mov_b32 s23, 0x00020000
    s_add_u32 s24, s6, 0x900000
    s_addc_u32 s25, s7, 0
    s_mov_b32 s26, 0x280000
    s_mov_b32 s27, 0x00020000
    v_lshlrev_b32 v33, 4, v1
    s_cmp_lt_u32 s3, 3
    s_cbranch_scc0 p3_dw
    s_waitcnt vmcnt(10)
    s_branch p3_dr
p3_dw:
    s_waitcnt vmcnt(6)
p3_dr:
    s_barrier
    ds_read_b128 v[52:55], v33 offset:28048
    ds_read_b128 v[56:59], v33 offset:29072
    ds_read_b128 v[60:63], v33 offset:30096
    ds_read_b128 v[64:67], v33 offset:31120
    ds_read_b128 v[68:71], v33 offset:32144
    ds_read_b128 v[72:75], v33 offset:33168
    ds_read_b128 v[76:79], v33 offset:34192
    ds_read_b128 v[80:83], v33 offset:35216
    ds_read_b128 v[84:87], v33 offset:36240
    ds_read_b128 v[88:91], v33 offset:37264
    ds_read_b128 v[92:95], v33 offset:38288
    ds_read_b128 v[96:99], v33 offset:39312
    v_and_b32 v4, 7, v3
    v_lshlrev_b32 v4, 8, v4
    v_add_u32 v4, s2, v4
    v_cvt_f32_u32 v34, v4
    v_mul_f32 v34, 0x3a000000, v34
    v_lshrrev_b32 v4, 1, v2
    v_lshlrev_b32 v4, 2, v4
    v_cvt_f32_u32 v6, v4
    v_and_b32 v4, 1, v2
    v_lshrrev_b32 v5, 3, v3
    v_cmp_eq_u32 s[40:41], v4, v5
    v_add_f32 v4, 0x00000000, v6
    v_mul_f32 v4, v4, v34
    v_cos_f32 v35, v4
    v_sin_f32 v50, v4
    s_nop 0
    v_cvt_pk_bf16_f32 v100, v35, -v50
    v_cvt_pk_bf16_f32 v104, v50, v35
    v_cndmask_b32 v100, 0, v100, s[40:41]
    v_cndmask_b32 v104, 0, v104, s[40:41]
    v_add_f32 v4, 0x3f800000, v6
    v_mul_f32 v4, v4, v34
    v_cos_f32 v35, v4
    v_sin_f32 v50, v4
    s_nop 0
    v_cvt_pk_bf16_f32 v101, v35, -v50
    v_cvt_pk_bf16_f32 v105, v50, v35
    v_cndmask_b32 v101, 0, v101, s[40:41]
    v_cndmask_b32 v105, 0, v105, s[40:41]
    v_add_f32 v4, 0x40000000, v6
    v_mul_f32 v4, v4, v34
    v_cos_f32 v35, v4
    v_sin_f32 v50, v4
    s_nop 0
    v_cvt_pk_bf16_f32 v102, v35, -v50
    v_cvt_pk_bf16_f32 v106, v50, v35
    v_cndmask_b32 v102, 0, v102, s[40:41]
    v_cndmask_b32 v106, 0, v106, s[40:41]
    v_add_f32 v4, 0x40400000, v6
    v_mul_f32 v4, v4, v34
    v_cos_f32 v35, v4
    v_sin_f32 v50, v4
    s_nop 0
    v_cvt_pk_bf16_f32 v103, v35, -v50
    v_cvt_pk_bf16_f32 v107, v50, v35
    v_cndmask_b32 v103, 0, v103, s[40:41]
    v_cndmask_b32 v107, 0, v107, s[40:41]
    v_and_b32 v4, 7, v3
    v_mul_u32_u24 v7, 2064, v4
    v_add_u32_sdwa v16, v24, v7 dst_sel:DWORD dst_unused:UNUSED_PAD src0_sel:WORD_0 src1_sel:DWORD
    v_add_u32_sdwa v17, v24, v7 dst_sel:DWORD dst_unused:UNUSED_PAD src0_sel:WORD_1 src1_sel:DWORD
    v_add_u32_sdwa v18, v25, v7 dst_sel:DWORD dst_unused:UNUSED_PAD src0_sel:WORD_0 src1_sel:DWORD
    v_add_u32_sdwa v19, v25, v7 dst_sel:DWORD dst_unused:UNUSED_PAD src0_sel:WORD_1 src1_sel:DWORD
    v_add_u32_sdwa v11, v26, v7 dst_sel:DWORD dst_unused:UNUSED_PAD src0_sel:WORD_0 src1_sel:DWORD
    v_lshlrev_b32 v4, 2, v26
    v_and_b32 v34, 0x80000000, v26
    v_cmp_gt_i32 s[42:43], 0, v4
    v_lshlrev_b32 v4, 1, v26
    v_and_b32 v50, 0x80000000, v4
    s_cmp_lt_u32 s3, 3
    s_cbranch_scc0 p3_dec
    v_add_u32_sdwa v20, v28, v7 dst_sel:DWORD dst_unused:UNUSED_PAD src0_sel:WORD_0 src1_sel:DWORD
    v_add_u32_sdwa v21, v28, v7 dst_sel:DWORD dst_unused:UNUSED_PAD src0_sel:WORD_1 src1_sel:DWORD
    v_add_u32_sdwa v22, v29, v7 dst_sel:DWORD dst_unused:UNUSED_PAD src0_sel:WORD_0 src1_sel:DWORD
    v_add_u32_sdwa v23, v29, v7 dst_sel:DWORD dst_unused:UNUSED_PAD src0_sel:WORD_1 src1_sel:DWORD
    v_add_u32_sdwa v27, v30, v7 dst_sel:DWORD dst_unused:UNUSED_PAD src0_sel:WORD_0 src1_sel:DWORD
    v_lshlrev_b32 v4, 2, v30
    v_and_b32 v35, 0x80000000, v30
    v_cmp_gt_i32 s[44:45], 0, v4
    v_lshlrev_b32 v4, 1, v30
    v_and_b32 v51, 0x80000000, v4
p3_dec:
    s_mul_i32 s9, s3, 2064
    v_min_u32 v4, 10, v3
    v_lshlrev_b32 v4, 4, v4
    v_lshl_add_u32 v4, v2, 8, v4
    v_add_u32 v24, s9, v4
    s_cmp_lt_u32 s3, 3
    s_cbranch_scc0 p3_t1w
    s_waitcnt vmcnt(6)
    s_branch p3_t1r
p3_t1w:
    s_waitcnt vmcnt(2)
p3_t1r:
    v_mfma_f32_16x16x32_bf16 v[108:111], v[36:39], v[100:103], 0
    v_mfma_f32_16x16x32_bf16 v[116:119], v[36:39], v[104:107], 0
    s_nop 7
    v_cvt_pk_bf16_f32 v12, v108, v116
    v_cvt_pk_bf16_f32 v13, v109, v117
    v_cvt_pk_bf16_f32 v14, v110, v118
    v_cvt_pk_bf16_f32 v15, v111, v119
    v_cndmask_b32 v4, v12, v14, s[42:43]
    v_xor_b32 v4, 0x80000000, v4
    v_xor_b32 v12, v34, v12
    v_xor_b32 v13, v34, v13
    v_xor_b32 v14, v34, v14
    v_xor_b32 v15, v50, v15
    ds_write_b32 v16, v12
    ds_write_b32 v17, v13
    ds_write_b32 v18, v14
    ds_write_b32 v19, v15
    ds_write_b32 v11, v4
    s_cmp_lt_u32 s3, 3
    s_cbranch_scc0 p3_join
    s_waitcnt vmcnt(2)
    v_mfma_f32_16x16x32_bf16 v[108:111], v[40:43], v[100:103], 0
    v_mfma_f32_16x16x32_bf16 v[116:119], v[40:43], v[104:107], 0
    s_nop 7
    v_cvt_pk_bf16_f32 v12, v108, v116
    v_cvt_pk_bf16_f32 v13, v109, v117
    v_cvt_pk_bf16_f32 v14, v110, v118
    v_cvt_pk_bf16_f32 v15, v111, v119
    v_cndmask_b32 v4, v12, v14, s[44:45]
    v_xor_b32 v4, 0x80000000, v4
    v_xor_b32 v12, v35, v12
    v_xor_b32 v13, v35, v13
    v_xor_b32 v14, v35, v14
    v_xor_b32 v15, v51, v15
    ds_write_b32 v20, v12
    ds_write_b32 v21, v13
    ds_write_b32 v22, v14
    ds_write_b32 v23, v15
    ds_write_b32 v27, v4
p3_join:
    s_waitcnt vmcnt(0) lgkmcnt(0)
    s_barrier
    s_add_u32 s56, s6, 0xc00000
    s_addc_u32 s57, s7, 0
    s_mov_b32 s58, 0x3c0000
    s_mov_b32 s59, 0x00020000
    s_bfe_u32 s60, s2, 0x20001
    s_mul_i32 s60, s60, 983040
    s_lshr_b32 s61, s2, 3
    s_mul_i32 s61, s61, 30720
    s_add_u32 s60, s60, s61
    v_lshlrev_b32 v25, 7, v0
    s_cmp_lt_u32 s3, 4
    s_cbranch_scc0 p3_nopfw
    buffer_load_dword v26, v25, s[56:59], s60 offen
p3_nopfw:
    ds_read_b128 v[36:39], v24
    ds_read_b128 v[40:43], v24 offset:1024
    ds_read_b128 v[16:19], v33 offset:40336
    ds_read_b128 v[20:23], v33 offset:41360
    ds_read_b128 v[100:103], v33 offset:42384
    s_waitcnt lgkmcnt(4)
    v_mfma_f32_16x16x32_bf16 v[108:111], v[36:39], v[52:55], 0
    v_mfma_f32_16x16x32_bf16 v[116:119], v[36:39], v[56:59], 0
    v_mfma_f32_16x16x32_bf16 v[112:115], v[36:39], v[68:71], 0
    v_mfma_f32_16x16x32_bf16 v[120:123], v[36:39], v[72:75], 0
    s_waitcnt lgkmcnt(3)
    v_mfma_f32_16x16x32_bf16 v[108:111], v[40:43], v[60:63], v[108:111]
    v_mfma_f32_16x16x32_bf16 v[116:119], v[40:43], v[64:67], v[116:119]
    v_mfma_f32_16x16x32_bf16 v[112:115], v[40:43], v[76:79], v[112:115]
    v_mfma_f32_16x16x32_bf16 v[120:123], v[40:43], v[80:83], v[120:123]
    s_nop 4
    v_mul_f32 v28, v108, v84
    v_mul_f32 v29, v116, v84
    v_fma_f32 v28, -v116, v92, v28
    v_fmac_f32 v29, v108, v92
    v_cvt_pk_bf16_f32 v36, v28, v29
    v_mul_f32 v28, v109, v85
    v_mul_f32 v29, v117, v85
    v_fma_f32 v28, -v117, v93, v28
    v_fmac_f32 v29, v109, v93
    v_cvt_pk_bf16_f32 v37, v28, v29
    v_mul_f32 v28, v110, v86
    v_mul_f32 v29, v118, v86
    v_fma_f32 v28, -v118, v94, v28
    v_fmac_f32 v29, v110, v94
    v_cvt_pk_bf16_f32 v38, v28, v29
    v_mul_f32 v28, v111, v87
    v_mul_f32 v29, v119, v87
    v_fma_f32 v28, -v119, v95, v28
    v_fmac_f32 v29, v111, v95
    v_cvt_pk_bf16_f32 v39, v28, v29
    v_mul_f32 v28, v112, v88
    v_mul_f32 v29, v120, v88
    v_fma_f32 v28, -v120, v96, v28
    v_fmac_f32 v29, v112, v96
    v_cvt_pk_bf16_f32 v40, v28, v29
    v_mul_f32 v28, v113, v89
    v_mul_f32 v29, v121, v89
    v_fma_f32 v28, -v121, v97, v28
    v_fmac_f32 v29, v113, v97
    v_cvt_pk_bf16_f32 v41, v28, v29
    v_mul_f32 v28, v114, v90
    v_mul_f32 v29, v122, v90
    v_fma_f32 v28, -v122, v98, v28
    v_fmac_f32 v29, v114, v98
    v_cvt_pk_bf16_f32 v42, v28, v29
    v_mul_f32 v28, v115, v91
    v_mul_f32 v29, v123, v91
    v_fma_f32 v28, -v123, v99, v28
    v_fmac_f32 v29, v115, v99
    v_cvt_pk_bf16_f32 v43, v28, v29
    s_waitcnt lgkmcnt(0)
    v_mfma_f32_16x16x32_bf16 v[108:111], v[36:39], v[16:19], 0
    v_mfma_f32_16x16x32_bf16 v[112:115], v[40:43], v[16:19], 0
    v_mfma_f32_16x16x32_bf16 v[116:119], v[36:39], v[20:23], 0
    v_mfma_f32_16x16x32_bf16 v[116:119], v[40:43], v[100:103], v[116:119]
    s_nop 4
    v_cvt_pk_bf16_f32 v4, v108, v109
    v_lshlrev_b32 v58, 16, v44
    v_and_b32 v59, 0xffff0000, v44
    v_lshlrev_b32 v60, 16, v4
    v_and_b32 v61, 0xffff0000, v4
    v_add_f32 v58, v58, v60
    v_add_f32 v59, v59, v61
    v_cvt_pk_bf16_f32 v52, v58, v59
    v_cvt_pk_bf16_f32 v4, v110, v111
    v_lshlrev_b32 v58, 16, v45
    v_and_b32 v59, 0xffff0000, v45
    v_lshlrev_b32 v60, 16, v4
    v_and_b32 v61, 0xffff0000, v4
    v_add_f32 v58, v58, v60
    v_add_f32 v59, v59, v61
    v_cvt_pk_bf16_f32 v53, v58, v59
    v_cvt_pk_bf16_f32 v4, v112, v113
    v_lshlrev_b32 v58, 16, v46
    v_and_b32 v59, 0xffff0000, v46
    v_lshlrev_b32 v60, 16, v4
    v_and_b32 v61, 0xffff0000, v4
    v_add_f32 v58, v58, v60
    v_add_f32 v59, v59, v61
    v_cvt_pk_bf16_f32 v54, v58, v59
    v_cvt_pk_bf16_f32 v4, v114, v115
    v_lshlrev_b32 v58, 16, v47
    v_and_b32 v59, 0xffff0000, v47
    v_lshlrev_b32 v60, 16, v4
    v_and_b32 v61, 0xffff0000, v4
    v_add_f32 v58, v58, v60
    v_add_f32 v59, v59, v61
    v_cvt_pk_bf16_f32 v55, v58, v59
    v_cvt_pk_bf16_f32 v4, v116, v117
    v_lshlrev_b32 v58, 16, v48
    v_and_b32 v59, 0xffff0000, v48
    v_lshlrev_b32 v60, 16, v4
    v_and_b32 v61, 0xffff0000, v4
    v_add_f32 v58, v58, v60
    v_add_f32 v59, v59, v61
    v_cvt_pk_bf16_f32 v56, v58, v59
    v_cvt_pk_bf16_f32 v4, v118, v119
    v_lshlrev_b32 v58, 16, v49
    v_and_b32 v59, 0xffff0000, v49
    v_lshlrev_b32 v60, 16, v4
    v_and_b32 v61, 0xffff0000, v4
    v_add_f32 v58, v58, v60
    v_add_f32 v59, v59, v61
    v_cvt_pk_bf16_f32 v57, v58, v59
    buffer_store_dwordx4 v[52:55], v31, s[20:23], s8 offen sc1
    buffer_store_dwordx2 v[56:57], v32, s[20:23], s8 offen sc1
    v_mov_b32 v44, v52
    v_mov_b32 v45, v53
    v_mov_b32 v46, v54
    v_mov_b32 v47, v55
    v_mov_b32 v48, v56
    v_mov_b32 v49, v57
    v_lshlrev_b32 v62, 16, v44
    v_and_b32 v63, 0xffff0000, v44
    v_lshlrev_b32 v64, 16, v45
    v_and_b32 v65, 0xffff0000, v45
    v_lshlrev_b32 v66, 16, v46
    v_and_b32 v67, 0xffff0000, v46
    v_lshlrev_b32 v68, 16, v47
    v_and_b32 v69, 0xffff0000, v47
    v_lshlrev_b32 v70, 16, v48
    v_and_b32 v71, 0xffff0000, v48
    v_lshlrev_b32 v72, 16, v49
    v_and_b32 v73, 0xffff0000, v49
    v_pk_add_f32 v[74:75], v[62:63], v[64:65]
    v_pk_add_f32 v[74:75], v[74:75], v[66:67]
    v_pk_add_f32 v[74:75], v[74:75], v[68:69]
    v_pk_add_f32 v[74:75], v[74:75], v[70:71]
    v_pk_add_f32 v[74:75], v[74:75], v[72:73]
    v_add_f32 v74, v74, v75
    s_nop 1
    v_add_f32_dpp v74, v74, v74 quad_perm:[1,0,3,2] row_mask:0xf bank_mask:0xf
    s_nop 1
    v_add_f32_dpp v74, v74, v74 quad_perm:[2,3,0,1] row_mask:0xf bank_mask:0xf
    s_nop 1
    v_add_f32_dpp v74, v74, v74 row_half_mirror row_mask:0xf bank_mask:0xf
    s_nop 1
    v_add_f32_dpp v74, v74, v74 row_mirror row_mask:0xf bank_mask:0xf
    s_nop 1
    v_add_f32_dpp v74, v74, v74 row_bcast:15 row_mask:0xa bank_mask:0xf
    s_nop 1
    v_add_f32_dpp v74, v74, v74 row_bcast:31 row_mask:0xc bank_mask:0xf
    s_nop 0
    v_readlane_b32 s36, v74, 63
    v_mov_b32 v76, 0xbacccccd
    s_nop 0
    v_mul_f32 v77, s36, v76
    v_mul_f32 v76, s36, v76
    v_cvt_pk_bf16_f32 v78, v77, v77
    v_pk_add_f32 v[80:81], v[62:63], v[76:77]
    v_and_b32 v79, 0xffff0000, v78
    v_and_b32 v78, 0xffff0000, v78
    v_pk_mul_f32 v[74:75], v[80:81], v[80:81]
    v_pk_add_f32 v[80:81], v[64:65], v[76:77]
    v_pk_fma_f32 v[74:75], v[80:81], v[80:81], v[74:75]
    v_pk_add_f32 v[80:81], v[66:67], v[76:77]
    v_pk_fma_f32 v[74:75], v[80:81], v[80:81], v[74:75]
    v_pk_add_f32 v[80:81], v[68:69], v[76:77]
    v_pk_fma_f32 v[74:75], v[80:81], v[80:81], v[74:75]
    v_pk_add_f32 v[80:81], v[70:71], v[76:77]
    v_cndmask_b32 v80, 0, v80, s[50:51]
    v_cndmask_b32 v81, 0, v81, s[50:51]
    v_pk_fma_f32 v[74:75], v[80:81], v[80:81], v[74:75]
    v_pk_add_f32 v[80:81], v[72:73], v[76:77]
    v_cndmask_b32 v80, 0, v80, s[50:51]
    v_cndmask_b32 v81, 0, v81, s[50:51]
    v_pk_fma_f32 v[74:75], v[80:81], v[80:81], v[74:75]
    v_add_f32 v74, v74, v75
    v_pk_add_f32 v[62:63], v[62:63], v[78:79]
    v_pk_add_f32 v[64:65], v[64:65], v[78:79]
    v_pk_add_f32 v[66:67], v[66:67], v[78:79]
    v_pk_add_f32 v[68:69], v[68:69], v[78:79]
    v_pk_add_f32 v[70:71], v[70:71], v[78:79]
    v_pk_add_f32 v[72:73], v[72:73], v[78:79]
    v_add_f32_dpp v74, v74, v74 quad_perm:[1,0,3,2] row_mask:0xf bank_mask:0xf
    s_nop 1
    v_add_f32_dpp v74, v74, v74 quad_perm:[2,3,0,1] row_mask:0xf bank_mask:0xf
    s_nop 1
    v_add_f32_dpp v74, v74, v74 row_half_mirror row_mask:0xf bank_mask:0xf
    s_nop 1
    v_add_f32_dpp v74, v74, v74 row_mirror row_mask:0xf bank_mask:0xf
    s_nop 1
    v_add_f32_dpp v74, v74, v74 row_bcast:15 row_mask:0xa bank_mask:0xf
    s_nop 1
    v_add_f32_dpp v74, v74, v74 row_bcast:31 row_mask:0xc bank_mask:0xf
    s_nop 0
    v_readlane_b32 s37, v74, 63
    v_cvt_pk_bf16_f32 v44, v62, v63
    v_cvt_pk_bf16_f32 v45, v64, v65
    v_cvt_pk_bf16_f32 v46, v66, v67
    v_cvt_pk_bf16_f32 v47, v68, v69
    v_cvt_pk_bf16_f32 v48, v70, v71
    v_cvt_pk_bf16_f32 v49, v72, v73
    v_mov_b32 v76, 0x3acccccd
    v_mul_f32 v76, s37, v76
    v_cvt_pk_bf16_f32 v76, v76, v76
    v_and_b32 v76, 0xffff0000, v76
    v_add_f32 v76, 0x3727c5ac, v76
    v_cvt_pk_bf16_f32 v76, v76, v76
    v_and_b32 v76, 0xffff0000, v76
    v_sqrt_f32 v76, v76
    v_lshlrev_b32 v62, 16, v44
    v_and_b32 v63, 0xffff0000, v44
    v_lshlrev_b32 v64, 16, v45
    v_and_b32 v65, 0xffff0000, v45
    v_lshlrev_b32 v66, 16, v46
    v_and_b32 v67, 0xffff0000, v46
    v_lshlrev_b32 v68, 16, v47
    v_and_b32 v69, 0xffff0000, v47
    v_lshlrev_b32 v70, 16, v48
    v_and_b32 v71, 0xffff0000, v48
    v_lshlrev_b32 v72, 16, v49
    v_and_b32 v73, 0xffff0000, v49
    v_cvt_pk_bf16_f32 v76, v76, v76
    v_and_b32 v76, 0xffff0000, v76
    v_rcp_f32 v77, v76
    v_rcp_f32 v76, v76
    s_nop 0
    v_pk_mul_f32 v[62:63], v[62:63], v[76:77]
    v_pk_mul_f32 v[64:65], v[64:65], v[76:77]
    v_pk_mul_f32 v[66:67], v[66:67], v[76:77]
    v_pk_mul_f32 v[68:69], v[68:69], v[76:77]
    v_pk_mul_f32 v[70:71], v[70:71], v[76:77]
    v_pk_mul_f32 v[72:73], v[72:73], v[76:77]
    v_cvt_pk_bf16_f32 v44, v62, v63
    v_cvt_pk_bf16_f32 v45, v64, v65
    v_cvt_pk_bf16_f32 v46, v66, v67
    v_cvt_pk_bf16_f32 v47, v68, v69
    v_cvt_pk_bf16_f32 v48, v70, v71
    v_cvt_pk_bf16_f32 v49, v72, v73
    s_lshl_b32 s9, s3, 4
    s_add_u32 s9, s9, 16512
    v_lshl_add_u32 v4, v3, 2, v2
    v_mul_u32_u24 v4, 144, v4
    v_add_u32 v30, s9, v4
    v_and_b32 v4, 3, v3
    v_lshl_add_u32 v4, v4, 2, v2
    v_add_u32 v4, 64, v4
    v_mul_u32_u24 v4, 144, v4
    v_lshrrev_b32 v5, 2, v3
    v_lshl_add_u32 v4, v5, 3, v4
    v_add_u32 v4, s9, v4
    v_mov_b32 v5, 28032
    v_cndmask_b32 v62, v5, v4, s[50:51]
    ds_write_b128 v30, v[44:47]
    ds_write_b64 v62, v[48:49]
    v_lshrrev_b32 v4, 3, v0
    v_and_b32 v5, 7, v0
    v_lshlrev_b32 v5, 4, v5
    v_mul_u32_u24 v6, 144, v4
    v_add_u32 v6, v6, v5
    v_lshl_add_u32 v7, v4, 8, v5
    s_lshr_b32 s9, s2, 1
    s_mul_i32 s9, s9, 20480
    s_and_b32 s33, s2, 1
    s_lshl_b32 s33, s33, 7
    s_add_u32 s9, s9, s33
    s_waitcnt lgkmcnt(0)
    s_barrier
    ds_read_b128 v[36:39], v6 offset:16512
    s_cmp_lt_u32 s3, 2
    s_cbranch_scc0 p3_last
    ds_read_b128 v[40:43], v6 offset:25728
    s_add_u32 s33, s9, 16384
    s_waitcnt lgkmcnt(0)
    buffer_store_dwordx4 v[40:43], v7, s[24:27], s33 offen sc1
p3_last:
    s_waitcnt lgkmcnt(0)
    buffer_store_dwordx4 v[36:39], v7, s[24:27], s9 offen sc1
p3_kernel_end:
    s_endpgm
.globl p4_kernel
.p2align 8
.type p4_kernel,@function
p4_kernel:
    s_cmp_ge_u32 s2, 256
    s_cbranch_scc1 p4_kernel_end
    s_load_dwordx2 s[6:7], s[0:1], 72
    v_and_b32 v4, 63, v0
    v_lshrrev_b32 v5, 6, v0
    s_nop 0
    v_readfirstlane_b32 s3, v5
    s_and_b32 s8, s2, 1
    s_lshl_b32 s8, s8, 3
    s_lshr_b32 s9, s2, 3
    s_and_b32 s10, s9, 7
    s_add_u32 s8, s8, s10
    s_lshr_b32 s9, s9, 3
    s_bfe_u32 s10, s2, 0x20001
    s_lshl_b32 s10, s10, 2
    s_add_u32 s9, s9, s10
    v_lshlrev_b32 v7, 4, v4
    s_mul_i32 s40, s3, 6144
    v_add_u32 v8, s40, v7
    s_lshl_b32 s41, s8, 3
    s_add_u32 s41, s41, s3
    s_mul_i32 s41, s41, 48
    s_mul_i32 s42, s9, 3
    s_add_u32 s41, s41, s42
    s_lshl_b32 s41, s41, 10
    s_cmp_ge_u32 s3, 4
    s_cbranch_scc0 p4_cons
    s_sub_u32 s36, s3, 4
    s_lshl_b32 s30, s8, 3
    s_lshl_b32 s31, s36, 1
    s_add_u32 s30, s30, s31
    s_mul_i32 s30, s30, 20480
    s_add_u32 s35, s30, 19456
    s_mul_i32 s31, s9, 245760
    s_mul_i32 s32, s36, 3072
    s_add_u32 s31, s31, s32
    s_lshl_b32 s33, s36, 11
    s_add_u32 s34, s32, 8192
    s_waitcnt lgkmcnt(0)
    s_add_u32 s12, s6, 0x900000
    s_addc_u32 s13, s7, 0
    s_mov_b32 s14, 0x280000
    s_mov_b32 s15, 0x00020000
    s_add_u32 s16, s6, 0xc00000
    s_addc_u32 s17, s7, 0
    s_mov_b32 s18, 0x3c0000
    s_mov_b32 s19, 0x00020000
    s_add_u32 s20, s6, 0x1200000
    s_addc_u32 s21, s7, 0
    s_mov_b32 s22, 0x600000
    s_mov_b32 s23, 0x00020000
    s_add_u32 m0, s33, 0
    s_nop 0
    buffer_load_dwordx4 v7, s[12:15], s30 offen lds
    buffer_load_dwordx4 v7, s[12:15], s35 offen offset:1024 lds
    s_add_u32 m0, s34, 0
    s_add_u32 s30, s30, 1024
    s_add_u32 s35, s35, 1024
    buffer_load_dwordx4 v7, s[16:19], s31 offen offset:0 lds
    buffer_load_dwordx4 v7, s[16:19], s31 offen offset:1024 lds
    buffer_load_dwordx4 v7, s[16:19], s31 offen offset:2048 lds
    s_add_u32 s31, s31, 12288
    s_add_u32 m0, s33, 20480
    s_nop 0
    buffer_load_dwordx4 v7, s[12:15], s30 offen lds
    buffer_load_dwordx4 v7, s[12:15], s35 offen offset:1024 lds
    s_add_u32 m0, s34, 20480
    s_add_u32 s30, s30, 1024
    s_add_u32 s35, s35, 1024
    buffer_load_dwordx4 v7, s[16:19], s31 offen offset:0 lds
    buffer_load_dwordx4 v7, s[16:19], s31 offen offset:1024 lds
    buffer_load_dwordx4 v7, s[16:19], s31 offen offset:2048 lds
    s_add_u32 s31, s31, 12288
    s_add_u32 m0, s33, 40960
    s_nop 0
    buffer_load_dwordx4 v7, s[12:15], s30 offen lds
    buffer_load_dwordx4 v7, s[12:15], s35 offen offset:1024 lds
    s_add_u32 m0, s34, 40960
    s_add_u32 s30, s30, 1024
    s_add_u32 s35, s35, 1024
    buffer_load_dwordx4 v7, s[16:19], s31 offen offset:0 lds
    buffer_load_dwordx4 v7, s[16:19], s31 offen offset:1024 lds
    buffer_load_dwordx4 v7, s[16:19], s31 offen offset:2048 lds
    s_add_u32 s31, s31, 12288
    s_add_u32 m0, s33, 61440
    s_nop 0
    buffer_load_dwordx4 v7, s[12:15], s30 offen lds
    buffer_load_dwordx4 v7, s[12:15], s35 offen offset:1024 lds
    s_add_u32 m0, s34, 61440
    s_add_u32 s30, s30, 1024
    s_add_u32 s35, s35, 1024
    buffer_load_dwordx4 v7, s[16:19], s31 offen offset:0 lds
    buffer_load_dwordx4 v7, s[16:19], s31 offen offset:1024 lds
    buffer_load_dwordx4 v7, s[16:19], s31 offen offset:2048 lds
    s_add_u32 s31, s31, 12288
    s_add_u32 m0, s33, 81920
    s_nop 0
    buffer_load_dwordx4 v7, s[12:15], s30 offen lds
    buffer_load_dwordx4 v7, s[12:15], s35 offen offset:1024 lds
    s_add_u32 m0, s34, 81920
    s_add_u32 s30, s30, 1024
    s_add_u32 s35, s35, 1024
    buffer_load_dwordx4 v7, s[16:19], s31 offen offset:0 lds
    buffer_load_dwordx4 v7, s[16:19], s31 offen offset:1024 lds
    buffer_load_dwordx4 v7, s[16:19], s31 offen offset:2048 lds
    s_add_u32 s31, s31, 12288
    s_add_u32 m0, s33, 102400
    s_nop 0
    buffer_load_dwordx4 v7, s[12:15], s30 offen lds
    buffer_load_dwordx4 v7, s[12:15], s35 offen offset:1024 lds
    s_add_u32 m0, s34, 102400
    s_add_u32 s30, s30, 1024
    s_add_u32 s35, s35, 1024
    buffer_load_dwordx4 v7, s[16:19], s31 offen offset:0 lds
    buffer_load_dwordx4 v7, s[16:19], s31 offen offset:1024 lds
    buffer_load_dwordx4 v7, s[16:19], s31 offen offset:2048 lds
    s_add_u32 s31, s31, 12288
    s_add_u32 s24, s6, 0x1000000
    s_addc_u32 s25, s7, 0
    s_mov_b32 s26, 0x1e0000
    s_mov_b32 s27, 0x00020000
    s_bfe_u32 s60, s2, 0x10002
    s_mul_i32 s60, s60, 983040
    s_lshr_b32 s61, s2, 3
    s_mul_i32 s61, s61, 30720
    s_add_u32 s60, s60, s61
    v_and_b32 v9, 255, v0
    v_lshlrev_b32 v9, 7, v9
    s_waitcnt vmcnt(25)
    s_barrier
    s_add_u32 m0, s33, 122880
    s_nop 0
    buffer_load_dwordx4 v7, s[12:15], s30 offen lds
    buffer_load_dwordx4 v7, s[12:15], s35 offen offset:1024 lds
    s_add_u32 m0, s34, 122880
    s_add_u32 s30, s30, 1024
    s_add_u32 s35, s35, 1024
    buffer_load_dwordx4 v7, s[16:19], s31 offen offset:0 lds
    buffer_load_dwordx4 v7, s[16:19], s31 offen offset:1024 lds
    buffer_load_dwordx4 v7, s[16:19], s31 offen offset:2048 lds
    s_add_u32 s31, s31, 12288
    s_waitcnt vmcnt(25)
    s_barrier
    s_add_u32 m0, s33, 0
    s_nop 0
    buffer_load_dwordx4 v7, s[12:15], s30 offen lds
    buffer_load_dwordx4 v7, s[12:15], s35 offen offset:1024 lds
    s_add_u32 m0, s34, 0
    s_add_u32 s30, s30, 1024
    s_add_u32 s35, s35, 1024
    buffer_load_dwordx4 v7, s[16:19], s31 offen offset:0 lds
    buffer_load_dwordx4 v7, s[16:19], s31 offen offset:1024 lds
    buffer_load_dwordx4 v7, s[16:19], s31 offen offset:2048 lds
    s_add_u32 s31, s31, 12288
    s_waitcnt vmcnt(25)
    s_barrier
    s_add_u32 m0, s33, 20480
    s_nop 0
    buffer_load_dwordx4 v7, s[12:15], s30 offen lds
    buffer_load_dwordx4 v7, s[12:15], s35 offen offset:1024 lds
    s_add_u32 m0, s34, 20480
    s_add_u32 s30, s30, 1024
    s_add_u32 s35, s35, 1024
    buffer_load_dwordx4 v7, s[16:19], s31 offen offset:0 lds
    buffer_load_dwordx4 v7, s[16:19], s31 offen offset:1024 lds
    buffer_load_dwordx4 v7, s[16:19], s31 offen offset:2048 lds
    s_add_u32 s31, s31, 12288
    s_waitcnt vmcnt(25)
    s_barrier
    s_add_u32 m0, s33, 40960
    s_nop 0
    buffer_load_dwordx4 v7, s[12:15], s30 offen lds
    buffer_load_dwordx4 v7, s[12:15], s35 offen offset:1024 lds
    s_add_u32 m0, s34, 40960
    s_add_u32 s30, s30, 1024
    s_add_u32 s35, s35, 1024
    buffer_load_dwordx4 v7, s[16:19], s31 offen offset:0 lds
    buffer_load_dwordx4 v7, s[16:19], s31 offen offset:1024 lds
    buffer_load_dwordx4 v7, s[16:19], s31 offen offset:2048 lds
    s_add_u32 s31, s31, 12288
    s_waitcnt vmcnt(25)
    s_barrier
    s_add_u32 m0, s33, 61440
    s_nop 0
    buffer_load_dwordx4 v7, s[12:15], s30 offen lds
    buffer_load_dwordx4 v7, s[12:15], s35 offen offset:1024 lds
    s_add_u32 m0, s34, 61440
    s_add_u32 s30, s30, 1024
    s_add_u32 s35, s35, 1024
    buffer_load_dwordx4 v7, s[16:19], s31 offen offset:0 lds
    buffer_load_dwordx4 v7, s[16:19], s31 offen offset:1024 lds
    buffer_load_dwordx4 v7, s[16:19], s31 offen offset:2048 lds
    s_add_u32 s31, s31, 12288
    s_waitcnt vmcnt(25)
    s_barrier
    s_add_u32 m0, s33, 81920
    s_nop 0
    buffer_load_dwordx4 v7, s[12:15], s30 offen lds
    buffer_load_dwordx4 v7, s[12:15], s35 offen offset:1024 lds
    s_add_u32 m0, s34, 81920
    s_add_u32 s30, s30, 1024
    s_add_u32 s35, s35, 1024
    buffer_load_dwordx4 v7, s[16:19], s31 offen offset:0 lds
    buffer_load_dwordx4 v7, s[16:19], s31 offen offset:1024 lds
    buffer_load_dwordx4 v7, s[16:19], s31 offen offset:2048 lds
    s_add_u32 s31, s31, 12288
    s_waitcnt vmcnt(25)
    s_barrier
    s_add_u32 m0, s33, 102400
    s_nop 0
    buffer_load_dwordx4 v7, s[12:15], s30 offen lds
    buffer_load_dwordx4 v7, s[12:15], s35 offen offset:1024 lds
    s_add_u32 m0, s34, 102400
    s_add_u32 s30, s30, 1024
    s_add_u32 s35, s35, 1024
    buffer_load_dwordx4 v7, s[16:19], s31 offen offset:0 lds
    buffer_load_dwordx4 v7, s[16:19], s31 offen offset:1024 lds
    buffer_load_dwordx4 v7, s[16:19], s31 offen offset:2048 lds
    s_add_u32 s31, s31, 12288
    s_waitcnt vmcnt(25)
    s_barrier
    s_add_u32 m0, s33, 122880
    s_nop 0
    buffer_load_dwordx4 v7, s[12:15], s30 offen lds
    buffer_load_dwordx4 v7, s[12:15], s35 offen offset:1024 lds
    s_add_u32 m0, s34, 122880
    s_add_u32 s30, s30, 1024
    s_add_u32 s35, s35, 1024
    buffer_load_dwordx4 v7, s[16:19], s31 offen offset:0 lds
    buffer_load_dwordx4 v7, s[16:19], s31 offen offset:1024 lds
    buffer_load_dwordx4 v7, s[16:19], s31 offen offset:2048 lds
    s_add_u32 s31, s31, 12288
    s_waitcnt vmcnt(25)
    s_barrier
    s_add_u32 m0, s33, 0
    s_nop 0
    buffer_load_dwordx4 v7, s[12:15], s30 offen lds
    buffer_load_dwordx4 v7, s[12:15], s35 offen offset:1024 lds
    s_add_u32 m0, s34, 0
    s_add_u32 s30, s30, 1024
    s_add_u32 s35, s35, 1024
    buffer_load_dwordx4 v7, s[16:19], s31 offen offset:0 lds
    buffer_load_dwordx4 v7, s[16:19], s31 offen offset:1024 lds
    buffer_load_dwordx4 v7, s[16:19], s31 offen offset:2048 lds
    s_add_u32 s31, s31, 12288
    s_waitcnt vmcnt(25)
    s_barrier
    s_add_u32 m0, s33, 20480
    s_nop 0
    buffer_load_dwordx4 v7, s[12:15], s30 offen lds
    buffer_load_dwordx4 v7, s[12:15], s35 offen offset:1024 lds
    s_add_u32 m0, s34, 20480
    s_add_u32 s30, s30, 1024
    s_add_u32 s35, s35, 1024
    buffer_load_dwordx4 v7, s[16:19], s31 offen offset:0 lds
    buffer_load_dwordx4 v7, s[16:19], s31 offen offset:1024 lds
    buffer_load_dwordx4 v7, s[16:19], s31 offen offset:2048 lds
    s_add_u32 s31, s31, 12288
    s_waitcnt vmcnt(25)
    s_barrier
    s_add_u32 m0, s33, 40960
    s_nop 0
    buffer_load_dwordx4 v7, s[12:15], s30 offen lds
    buffer_load_dwordx4 v7, s[12:15], s35 offen offset:1024 lds
    s_add_u32 m0, s34, 40960
    s_add_u32 s30, s30, 1024
    s_add_u32 s35, s35, 1024
    buffer_load_dwordx4 v7, s[16:19], s31 offen offset:0 lds
    buffer_load_dwordx4 v7, s[16:19], s31 offen offset:1024 lds
    buffer_load_dwordx4 v7, s[16:19], s31 offen offset:2048 lds
    s_add_u32 s31, s31, 12288
    s_waitcnt vmcnt(25)
    s_barrier
    s_add_u32 m0, s33, 61440
    s_nop 0
    buffer_load_dwordx4 v7, s[12:15], s30 offen lds
    buffer_load_dwordx4 v7, s[12:15], s35 offen offset:1024 lds
    s_add_u32 m0, s34, 61440
    s_add_u32 s30, s30, 1024
    s_add_u32 s35, s35, 1024
    buffer_load_dwordx4 v7, s[16:19], s31 offen offset:0 lds
    buffer_load_dwordx4 v7, s[16:19], s31 offen offset:1024 lds
    buffer_load_dwordx4 v7, s[16:19], s31 offen offset:2048 lds
    s_add_u32 s31, s31, 12288
    s_waitcnt vmcnt(25)
    s_barrier
    s_add_u32 m0, s33, 81920
    s_nop 0
    buffer_load_dwordx4 v7, s[12:15], s30 offen lds
    buffer_load_dwordx4 v7, s[12:15], s35 offen offset:1024 lds
    s_add_u32 m0, s34, 81920
    s_add_u32 s30, s30, 1024
    s_add_u32 s35, s35, 1024
    buffer_load_dwordx4 v7, s[16:19], s31 offen offset:0 lds
    buffer_load_dwordx4 v7, s[16:19], s31 offen offset:1024 lds
    buffer_load_dwordx4 v7, s[16:19], s31 offen offset:2048 lds
    s_add_u32 s31, s31, 12288
    s_waitcnt vmcnt(25)
    s_barrier
    s_add_u32 m0, s33, 102400
    s_nop 0
    buffer_load_dwordx4 v7, s[12:15], s30 offen lds
    buffer_load_dwordx4 v7, s[12:15], s35 offen offset:1024 lds
    s_add_u32 m0, s34, 102400
    s_add_u32 s30, s30, 1024
    s_add_u32 s35, s35, 1024
    buffer_load_dwordx4 v7, s[16:19], s31 offen offset:0 lds
    buffer_load_dwordx4 v7, s[16:19], s31 offen offset:1024 lds
    buffer_load_dwordx4 v7, s[16:19], s31 offen offset:2048 lds
    s_add_u32 s31, s31, 12288
    buffer_load_dword v10, v9, s[24:27], s60 offen
    s_waitcnt vmcnt(26)
    s_barrier
    s_waitcnt vmcnt(21)
    s_barrier
    s_waitcnt vmcnt(16)
    s_barrier
    s_waitcnt vmcnt(11)
    s_barrier
    s_waitcnt vmcnt(6)
    s_barrier
    s_waitcnt vmcnt(1)
    s_barrier
    s_branch p4_epi
p4_cons:
    s_and_b32 s30, s3, 1
    s_lshr_b32 s31, s3, 1
    s_lshl_b32 s32, s30, 12
    v_add_u32 v12, s32, v7
    s_mul_i32 s32, s31, 6144
    s_add_u32 s32, s32, 8192
    v_add_u32 v11, s32, v7
    v_add_u32 v13, 61440, v11
    v_add_u32 v18, 61440, v12
    v_add_u32 v17, 122880, v11
    v_add_u32 v19, 122880, v12
    s_mul_i32 s32, s30, 24
    s_mul_i32 s33, s31, 3
    s_add_u32 s32, s32, s33
    s_lshl_b32 s32, s32, 10
    v_add_u32 v20, s32, v7
    s_waitcnt lgkmcnt(0)
    s_add_u32 s20, s6, 0x1200000
    s_addc_u32 s21, s7, 0
    s_mov_b32 s22, 0x600000
    s_mov_b32 s23, 0x00020000
    s_barrier
    ds_read_b128 v[168:171], v12 offset:0
    ds_read_b128 v[120:123], v11 offset:0
    ds_read_b128 v[124:127], v11 offset:1024
    ds_read_b128 v[172:175], v12 offset:1024
    ds_read_b128 v[128:131], v11 offset:2048
    ds_read_b128 v[132:135], v11 offset:3072
    ds_read_b128 v[176:179], v12 offset:2048
    ds_read_b128 v[136:139], v11 offset:4096
    ds_read_b128 v[140:143], v11 offset:5120
    ds_read_b128 v[180:183], v12 offset:3072
    s_waitcnt lgkmcnt(0)
    s_barrier
    v_mfma_f32_16x16x32_bf16 v[24:27], v[120:123], v[168:171], 0
    ds_read_b128 v[184:187], v12 offset:20480
    v_mfma_f32_16x16x32_bf16 v[28:31], v[124:127], v[168:171], 0
    v_mfma_f32_16x16x32_bf16 v[48:51], v[120:123], v[172:175], 0
    ds_read_b128 v[144:147], v11 offset:20480
    v_mfma_f32_16x16x32_bf16 v[52:55], v[124:127], v[172:175], 0
    v_mfma_f32_16x16x32_bf16 v[72:75], v[120:123], v[176:179], 0
    ds_read_b128 v[148:151], v11 offset:21504
    v_mfma_f32_16x16x32_bf16 v[76:79], v[124:127], v[176:179], 0
    v_mfma_f32_16x16x32_bf16 v[96:99], v[120:123], v[180:183], 0
    ds_read_b128 v[188:191], v12 offset:21504
    v_mfma_f32_16x16x32_bf16 v[100:103], v[124:127], v[180:183], 0
    v_mfma_f32_16x16x32_bf16 v[32:35], v[128:131], v[168:171], 0
    ds_read_b128 v[152:155], v11 offset:22528
    v_mfma_f32_16x16x32_bf16 v[36:39], v[132:135], v[168:171], 0
    v_mfma_f32_16x16x32_bf16 v[56:59], v[128:131], v[172:175], 0
    ds_read_b128 v[156:159], v11 offset:23552
    v_mfma_f32_16x16x32_bf16 v[60:63], v[132:135], v[172:175], 0
    v_mfma_f32_16x16x32_bf16 v[80:83], v[128:131], v[176:179], 0
    ds_read_b128 v[192:195], v12 offset:22528
    v_mfma_f32_16x16x32_bf16 v[84:87], v[132:135], v[176:179], 0
    v_mfma_f32_16x16x32_bf16 v[104:107], v[128:131], v[180:183], 0
    ds_read_b128 v[160:163], v11 offset:24576
    v_mfma_f32_16x16x32_bf16 v[108:111], v[132:135], v[180:183], 0
    v_mfma_f32_16x16x32_bf16 v[40:43], v[136:139], v[168:171], 0
    ds_read_b128 v[164:167], v11 offset:25600
    v_mfma_f32_16x16x32_bf16 v[44:47], v[140:143], v[168:171], 0
    v_mfma_f32_16x16x32_bf16 v[64:67], v[136:139], v[172:175], 0
    ds_read_b128 v[196:199], v12 offset:23552
    v_mfma_f32_16x16x32_bf16 v[68:71], v[140:143], v[172:175], 0
    v_mfma_f32_16x16x32_bf16 v[88:91], v[136:139], v[176:179], 0
    v_mfma_f32_16x16x32_bf16 v[92:95], v[140:143], v[176:179], 0
    v_mfma_f32_16x16x32_bf16 v[112:115], v[136:139], v[180:183], 0
    v_mfma_f32_16x16x32_bf16 v[116:119], v[140:143], v[180:183], 0
    s_waitcnt lgkmcnt(0)
    s_barrier
    v_mfma_f32_16x16x32_bf16 v[24:27], v[144:147], v[184:187], v[24:27]
    ds_read_b128 v[168:171], v12 offset:40960
    v_mfma_f32_16x16x32_bf16 v[28:31], v[148:151], v[184:187], v[28:31]
    v_mfma_f32_16x16x32_bf16 v[48:51], v[144:147], v[188:191], v[48:51]
    ds_read_b128 v[120:123], v11 offset:40960
    v_mfma_f32_16x16x32_bf16 v[52:55], v[148:151], v[188:191], v[52:55]
    v_mfma_f32_16x16x32_bf16 v[72:75], v[144:147], v[192:195], v[72:75]
    ds_read_b128 v[124:127], v11 offset:41984
    v_mfma_f32_16x16x32_bf16 v[76:79], v[148:151], v[192:195], v[76:79]
    v_mfma_f32_16x16x32_bf16 v[96:99], v[144:147], v[196:199], v[96:99]
    ds_read_b128 v[172:175], v12 offset:41984
    v_mfma_f32_16x16x32_bf16 v[100:103], v[148:151], v[196:199], v[100:103]
    v_mfma_f32_16x16x32_bf16 v[32:35], v[152:155], v[184:187], v[32:35]
    ds_read_b128 v[128:131], v11 offset:43008
    v_mfma_f32_16x16x32_bf16 v[36:39], v[156:159], v[184:187], v[36:39]
    v_mfma_f32_16x16x32_bf16 v[56:59], v[152:155], v[188:191], v[56:59]
    ds_read_b128 v[132:135], v11 offset:44032
    v_mfma_f32_16x16x32_bf16 v[60:63], v[156:159], v[188:191], v[60:63]
    v_mfma_f32_16x16x32_bf16 v[80:83], v[152:155], v[192:195], v[80:83]
    ds_read_b128 v[176:179], v12 offset:43008
    v_mfma_f32_16x16x32_bf16 v[84:87], v[156:159], v[192:195], v[84:87]
    v_mfma_f32_16x16x32_bf16 v[104:107], v[152:155], v[196:199], v[104:107]
    ds_read_b128 v[136:139], v11 offset:45056
    v_mfma_f32_16x16x32_bf16 v[108:111], v[156:159], v[196:199], v[108:111]
    v_mfma_f32_16x16x32_bf16 v[40:43], v[160:163], v[184:187], v[40:43]
    ds_read_b128 v[140:143], v11 offset:46080
    v_mfma_f32_16x16x32_bf16 v[44:47], v[164:167], v[184:187], v[44:47]
    v_mfma_f32_16x16x32_bf16 v[64:67], v[160:163], v[188:191], v[64:67]
    ds_read_b128 v[180:183], v12 offset:44032
    v_mfma_f32_16x16x32_bf16 v[68:71], v[164:167], v[188:191], v[68:71]
    v_mfma_f32_16x16x32_bf16 v[88:91], v[160:163], v[192:195], v[88:91]
    v_mfma_f32_16x16x32_bf16 v[92:95], v[164:167], v[192:195], v[92:95]
    v_mfma_f32_16x16x32_bf16 v[112:115], v[160:163], v[196:199], v[112:115]
    v_mfma_f32_16x16x32_bf16 v[116:119], v[164:167], v[196:199], v[116:119]
    s_waitcnt lgkmcnt(0)
    s_barrier
    v_mfma_f32_16x16x32_bf16 v[24:27], v[120:123], v[168:171], v[24:27]
    ds_read_b128 v[184:187], v18 offset:0
    v_mfma_f32_16x16x32_bf16 v[28:31], v[124:127], v[168:171], v[28:31]
    v_mfma_f32_16x16x32_bf16 v[48:51], v[120:123], v[172:175], v[48:51]
    ds_read_b128 v[144:147], v13 offset:0
    v_mfma_f32_16x16x32_bf16 v[52:55], v[124:127], v[172:175], v[52:55]
    v_mfma_f32_16x16x32_bf16 v[72:75], v[120:123], v[176:179], v[72:75]
    ds_read_b128 v[148:151], v13 offset:1024
    v_mfma_f32_16x16x32_bf16 v[76:79], v[124:127], v[176:179], v[76:79]
    v_mfma_f32_16x16x32_bf16 v[96:99], v[120:123], v[180:183], v[96:99]
    ds_read_b128 v[188:191], v18 offset:1024
    v_mfma_f32_16x16x32_bf16 v[100:103], v[124:127], v[180:183], v[100:103]
    v_mfma_f32_16x16x32_bf16 v[32:35], v[128:131], v[168:171], v[32:35]
    ds_read_b128 v[152:155], v13 offset:2048
    v_mfma_f32_16x16x32_bf16 v[36:39], v[132:135], v[168:171], v[36:39]
    v_mfma_f32_16x16x32_bf16 v[56:59], v[128:131], v[172:175], v[56:59]
    ds_read_b128 v[156:159], v13 offset:3072
    v_mfma_f32_16x16x32_bf16 v[60:63], v[132:135], v[172:175], v[60:63]
    v_mfma_f32_16x16x32_bf16 v[80:83], v[128:131], v[176:179], v[80:83]
    ds_read_b128 v[192:195], v18 offset:2048
    v_mfma_f32_16x16x32_bf16 v[84:87], v[132:135], v[176:179], v[84:87]
    v_mfma_f32_16x16x32_bf16 v[104:107], v[128:131], v[180:183], v[104:107]
    ds_read_b128 v[160:163], v13 offset:4096
    v_mfma_f32_16x16x32_bf16 v[108:111], v[132:135], v[180:183], v[108:111]
    v_mfma_f32_16x16x32_bf16 v[40:43], v[136:139], v[168:171], v[40:43]
    ds_read_b128 v[164:167], v13 offset:5120
    v_mfma_f32_16x16x32_bf16 v[44:47], v[140:143], v[168:171], v[44:47]
    v_mfma_f32_16x16x32_bf16 v[64:67], v[136:139], v[172:175], v[64:67]
    ds_read_b128 v[196:199], v18 offset:3072
    v_mfma_f32_16x16x32_bf16 v[68:71], v[140:143], v[172:175], v[68:71]
    v_mfma_f32_16x16x32_bf16 v[88:91], v[136:139], v[176:179], v[88:91]
    v_mfma_f32_16x16x32_bf16 v[92:95], v[140:143], v[176:179], v[92:95]
    v_mfma_f32_16x16x32_bf16 v[112:115], v[136:139], v[180:183], v[112:115]
    v_mfma_f32_16x16x32_bf16 v[116:119], v[140:143], v[180:183], v[116:119]
    s_waitcnt lgkmcnt(0)
    s_barrier
    v_mfma_f32_16x16x32_bf16 v[24:27], v[144:147], v[184:187], v[24:27]
    ds_read_b128 v[168:171], v18 offset:20480
    v_mfma_f32_16x16x32_bf16 v[28:31], v[148:151], v[184:187], v[28:31]
    v_mfma_f32_16x16x32_bf16 v[48:51], v[144:147], v[188:191], v[48:51]
    ds_read_b128 v[120:123], v13 offset:20480
    v_mfma_f32_16x16x32_bf16 v[52:55], v[148:151], v[188:191], v[52:55]
    v_mfma_f32_16x16x32_bf16 v[72:75], v[144:147], v[192:195], v[72:75]
    ds_read_b128 v[124:127], v13 offset:21504
    v_mfma_f32_16x16x32_bf16 v[76:79], v[148:151], v[192:195], v[76:79]
    v_mfma_f32_16x16x32_bf16 v[96:99], v[144:147], v[196:199], v[96:99]
    ds_read_b128 v[172:175], v18 offset:21504
    v_mfma_f32_16x16x32_bf16 v[100:103], v[148:151], v[196:199], v[100:103]
    v_mfma_f32_16x16x32_bf16 v[32:35], v[152:155], v[184:187], v[32:35]
    ds_read_b128 v[128:131], v13 offset:22528
    v_mfma_f32_16x16x32_bf16 v[36:39], v[156:159], v[184:187], v[36:39]
    v_mfma_f32_16x16x32_bf16 v[56:59], v[152:155], v[188:191], v[56:59]
    ds_read_b128 v[132:135], v13 offset:23552
    v_mfma_f32_16x16x32_bf16 v[60:63], v[156:159], v[188:191], v[60:63]
    v_mfma_f32_16x16x32_bf16 v[80:83], v[152:155], v[192:195], v[80:83]
    ds_read_b128 v[176:179], v18 offset:22528
    v_mfma_f32_16x16x32_bf16 v[84:87], v[156:159], v[192:195], v[84:87]
    v_mfma_f32_16x16x32_bf16 v[104:107], v[152:155], v[196:199], v[104:107]
    ds_read_b128 v[136:139], v13 offset:24576
    v_mfma_f32_16x16x32_bf16 v[108:111], v[156:159], v[196:199], v[108:111]
    v_mfma_f32_16x16x32_bf16 v[40:43], v[160:163], v[184:187], v[40:43]
    ds_read_b128 v[140:143], v13 offset:25600
    v_mfma_f32_16x16x32_bf16 v[44:47], v[164:167], v[184:187], v[44:47]
    v_mfma_f32_16x16x32_bf16 v[64:67], v[160:163], v[188:191], v[64:67]
    ds_read_b128 v[180:183], v18 offset:23552
    v_mfma_f32_16x16x32_bf16 v[68:71], v[164:167], v[188:191], v[68:71]
    v_mfma_f32_16x16x32_bf16 v[88:91], v[160:163], v[192:195], v[88:91]
    v_mfma_f32_16x16x32_bf16 v[92:95], v[164:167], v[192:195], v[92:95]
    v_mfma_f32_16x16x32_bf16 v[112:115], v[160:163], v[196:199], v[112:115]
    v_mfma_f32_16x16x32_bf16 v[116:119], v[164:167], v[196:199], v[116:119]
    s_waitcnt lgkmcnt(0)
    s_barrier
    v_mfma_f32_16x16x32_bf16 v[24:27], v[120:123], v[168:171], v[24:27]
    ds_read_b128 v[184:187], v18 offset:40960
    v_mfma_f32_16x16x32_bf16 v[28:31], v[124:127], v[168:171], v[28:31]
    v_mfma_f32_16x16x32_bf16 v[48:51], v[120:123], v[172:175], v[48:51]
    ds_read_b128 v[144:147], v13 offset:40960
    v_mfma_f32_16x16x32_bf16 v[52:55], v[124:127], v[172:175], v[52:55]
    v_mfma_f32_16x16x32_bf16 v[72:75], v[120:123], v[176:179], v[72:75]
    ds_read_b128 v[148:151], v13 offset:41984
    v_mfma_f32_16x16x32_bf16 v[76:79], v[124:127], v[176:179], v[76:79]
    v_mfma_f32_16x16x32_bf16 v[96:99], v[120:123], v[180:183], v[96:99]
    ds_read_b128 v[188:191], v18 offset:41984
    v_mfma_f32_16x16x32_bf16 v[100:103], v[124:127], v[180:183], v[100:103]
    v_mfma_f32_16x16x32_bf16 v[32:35], v[128:131], v[168:171], v[32:35]
    ds_read_b128 v[152:155], v13 offset:43008
    v_mfma_f32_16x16x32_bf16 v[36:39], v[132:135], v[168:171], v[36:39]
    v_mfma_f32_16x16x32_bf16 v[56:59], v[128:131], v[172:175], v[56:59]
    ds_read_b128 v[156:159], v13 offset:44032
    v_mfma_f32_16x16x32_bf16 v[60:63], v[132:135], v[172:175], v[60:63]
    v_mfma_f32_16x16x32_bf16 v[80:83], v[128:131], v[176:179], v[80:83]
    ds_read_b128 v[192:195], v18 offset:43008
    v_mfma_f32_16x16x32_bf16 v[84:87], v[132:135], v[176:179], v[84:87]
    v_mfma_f32_16x16x32_bf16 v[104:107], v[128:131], v[180:183], v[104:107]
    ds_read_b128 v[160:163], v13 offset:45056
    v_mfma_f32_16x16x32_bf16 v[108:111], v[132:135], v[180:183], v[108:111]
    v_mfma_f32_16x16x32_bf16 v[40:43], v[136:139], v[168:171], v[40:43]
    ds_read_b128 v[164:167], v13 offset:46080
    v_mfma_f32_16x16x32_bf16 v[44:47], v[140:143], v[168:171], v[44:47]
    v_mfma_f32_16x16x32_bf16 v[64:67], v[136:139], v[172:175], v[64:67]
    ds_read_b128 v[196:199], v18 offset:44032
    v_mfma_f32_16x16x32_bf16 v[68:71], v[140:143], v[172:175], v[68:71]
    v_mfma_f32_16x16x32_bf16 v[88:91], v[136:139], v[176:179], v[88:91]
    v_mfma_f32_16x16x32_bf16 v[92:95], v[140:143], v[176:179], v[92:95]
    v_mfma_f32_16x16x32_bf16 v[112:115], v[136:139], v[180:183], v[112:115]
    v_mfma_f32_16x16x32_bf16 v[116:119], v[140:143], v[180:183], v[116:119]
    s_waitcnt lgkmcnt(0)
    s_barrier
    v_mfma_f32_16x16x32_bf16 v[24:27], v[144:147], v[184:187], v[24:27]
    ds_read_b128 v[168:171], v19 offset:0
    v_mfma_f32_16x16x32_bf16 v[28:31], v[148:151], v[184:187], v[28:31]
    v_mfma_f32_16x16x32_bf16 v[48:51], v[144:147], v[188:191], v[48:51]
    ds_read_b128 v[120:123], v17 offset:0
    v_mfma_f32_16x16x32_bf16 v[52:55], v[148:151], v[188:191], v[52:55]
    v_mfma_f32_16x16x32_bf16 v[72:75], v[144:147], v[192:195], v[72:75]
    ds_read_b128 v[124:127], v17 offset:1024
    v_mfma_f32_16x16x32_bf16 v[76:79], v[148:151], v[192:195], v[76:79]
    v_mfma_f32_16x16x32_bf16 v[96:99], v[144:147], v[196:199], v[96:99]
    ds_read_b128 v[172:175], v19 offset:1024
    v_mfma_f32_16x16x32_bf16 v[100:103], v[148:151], v[196:199], v[100:103]
    v_mfma_f32_16x16x32_bf16 v[32:35], v[152:155], v[184:187], v[32:35]
    ds_read_b128 v[128:131], v17 offset:2048
    v_mfma_f32_16x16x32_bf16 v[36:39], v[156:159], v[184:187], v[36:39]
    v_mfma_f32_16x16x32_bf16 v[56:59], v[152:155], v[188:191], v[56:59]
    ds_read_b128 v[132:135], v17 offset:3072
    v_mfma_f32_16x16x32_bf16 v[60:63], v[156:159], v[188:191], v[60:63]
    v_mfma_f32_16x16x32_bf16 v[80:83], v[152:155], v[192:195], v[80:83]
    ds_read_b128 v[176:179], v19 offset:2048
    v_mfma_f32_16x16x32_bf16 v[84:87], v[156:159], v[192:195], v[84:87]
    v_mfma_f32_16x16x32_bf16 v[104:107], v[152:155], v[196:199], v[104:107]
    ds_read_b128 v[136:139], v17 offset:4096
    v_mfma_f32_16x16x32_bf16 v[108:111], v[156:159], v[196:199], v[108:111]
    v_mfma_f32_16x16x32_bf16 v[40:43], v[160:163], v[184:187], v[40:43]
    ds_read_b128 v[140:143], v17 offset:5120
    v_mfma_f32_16x16x32_bf16 v[44:47], v[164:167], v[184:187], v[44:47]
    v_mfma_f32_16x16x32_bf16 v[64:67], v[160:163], v[188:191], v[64:67]
    ds_read_b128 v[180:183], v19 offset:3072
    v_mfma_f32_16x16x32_bf16 v[68:71], v[164:167], v[188:191], v[68:71]
    v_mfma_f32_16x16x32_bf16 v[88:91], v[160:163], v[192:195], v[88:91]
    v_mfma_f32_16x16x32_bf16 v[92:95], v[164:167], v[192:195], v[92:95]
    v_mfma_f32_16x16x32_bf16 v[112:115], v[160:163], v[196:199], v[112:115]
    v_mfma_f32_16x16x32_bf16 v[116:119], v[164:167], v[196:199], v[116:119]
    s_waitcnt lgkmcnt(0)
    s_barrier
    v_mfma_f32_16x16x32_bf16 v[24:27], v[120:123], v[168:171], v[24:27]
    ds_read_b128 v[184:187], v12 offset:0
    v_mfma_f32_16x16x32_bf16 v[28:31], v[124:127], v[168:171], v[28:31]
    v_mfma_f32_16x16x32_bf16 v[48:51], v[120:123], v[172:175], v[48:51]
    ds_read_b128 v[144:147], v11 offset:0
    v_mfma_f32_16x16x32_bf16 v[52:55], v[124:127], v[172:175], v[52:55]
    v_mfma_f32_16x16x32_bf16 v[72:75], v[120:123], v[176:179], v[72:75]
    ds_read_b128 v[148:151], v11 offset:1024
    v_mfma_f32_16x16x32_bf16 v[76:79], v[124:127], v[176:179], v[76:79]
    v_mfma_f32_16x16x32_bf16 v[96:99], v[120:123], v[180:183], v[96:99]
    ds_read_b128 v[188:191], v12 offset:1024
    v_mfma_f32_16x16x32_bf16 v[100:103], v[124:127], v[180:183], v[100:103]
    v_mfma_f32_16x16x32_bf16 v[32:35], v[128:131], v[168:171], v[32:35]
    ds_read_b128 v[152:155], v11 offset:2048
    v_mfma_f32_16x16x32_bf16 v[36:39], v[132:135], v[168:171], v[36:39]
    v_mfma_f32_16x16x32_bf16 v[56:59], v[128:131], v[172:175], v[56:59]
    ds_read_b128 v[156:159], v11 offset:3072
    v_mfma_f32_16x16x32_bf16 v[60:63], v[132:135], v[172:175], v[60:63]
    v_mfma_f32_16x16x32_bf16 v[80:83], v[128:131], v[176:179], v[80:83]
    ds_read_b128 v[192:195], v12 offset:2048
    v_mfma_f32_16x16x32_bf16 v[84:87], v[132:135], v[176:179], v[84:87]
    v_mfma_f32_16x16x32_bf16 v[104:107], v[128:131], v[180:183], v[104:107]
    ds_read_b128 v[160:163], v11 offset:4096
    v_mfma_f32_16x16x32_bf16 v[108:111], v[132:135], v[180:183], v[108:111]
    v_mfma_f32_16x16x32_bf16 v[40:43], v[136:139], v[168:171], v[40:43]
    ds_read_b128 v[164:167], v11 offset:5120
    v_mfma_f32_16x16x32_bf16 v[44:47], v[140:143], v[168:171], v[44:47]
    v_mfma_f32_16x16x32_bf16 v[64:67], v[136:139], v[172:175], v[64:67]
    ds_read_b128 v[196:199], v12 offset:3072
    v_mfma_f32_16x16x32_bf16 v[68:71], v[140:143], v[172:175], v[68:71]
    v_mfma_f32_16x16x32_bf16 v[88:91], v[136:139], v[176:179], v[88:91]
    v_mfma_f32_16x16x32_bf16 v[92:95], v[140:143], v[176:179], v[92:95]
    v_mfma_f32_16x16x32_bf16 v[112:115], v[136:139], v[180:183], v[112:115]
    v_mfma_f32_16x16x32_bf16 v[116:119], v[140:143], v[180:183], v[116:119]
    s_waitcnt lgkmcnt(0)
    s_barrier
    v_mfma_f32_16x16x32_bf16 v[24:27], v[144:147], v[184:187], v[24:27]
    ds_read_b128 v[168:171], v12 offset:20480
    v_mfma_f32_16x16x32_bf16 v[28:31], v[148:151], v[184:187], v[28:31]
    v_mfma_f32_16x16x32_bf16 v[48:51], v[144:147], v[188:191], v[48:51]
    ds_read_b128 v[120:123], v11 offset:20480
    v_mfma_f32_16x16x32_bf16 v[52:55], v[148:151], v[188:191], v[52:55]
    v_mfma_f32_16x16x32_bf16 v[72:75], v[144:147], v[192:195], v[72:75]
    ds_read_b128 v[124:127], v11 offset:21504
    v_mfma_f32_16x16x32_bf16 v[76:79], v[148:151], v[192:195], v[76:79]
    v_mfma_f32_16x16x32_bf16 v[96:99], v[144:147], v[196:199], v[96:99]
    ds_read_b128 v[172:175], v12 offset:21504
    v_mfma_f32_16x16x32_bf16 v[100:103], v[148:151], v[196:199], v[100:103]
    v_mfma_f32_16x16x32_bf16 v[32:35], v[152:155], v[184:187], v[32:35]
    ds_read_b128 v[128:131], v11 offset:22528
    v_mfma_f32_16x16x32_bf16 v[36:39], v[156:159], v[184:187], v[36:39]
    v_mfma_f32_16x16x32_bf16 v[56:59], v[152:155], v[188:191], v[56:59]
    ds_read_b128 v[132:135], v11 offset:23552
    v_mfma_f32_16x16x32_bf16 v[60:63], v[156:159], v[188:191], v[60:63]
    v_mfma_f32_16x16x32_bf16 v[80:83], v[152:155], v[192:195], v[80:83]
    ds_read_b128 v[176:179], v12 offset:22528
    v_mfma_f32_16x16x32_bf16 v[84:87], v[156:159], v[192:195], v[84:87]
    v_mfma_f32_16x16x32_bf16 v[104:107], v[152:155], v[196:199], v[104:107]
    ds_read_b128 v[136:139], v11 offset:24576
    v_mfma_f32_16x16x32_bf16 v[108:111], v[156:159], v[196:199], v[108:111]
    v_mfma_f32_16x16x32_bf16 v[40:43], v[160:163], v[184:187], v[40:43]
    ds_read_b128 v[140:143], v11 offset:25600
    v_mfma_f32_16x16x32_bf16 v[44:47], v[164:167], v[184:187], v[44:47]
    v_mfma_f32_16x16x32_bf16 v[64:67], v[160:163], v[188:191], v[64:67]
    ds_read_b128 v[180:183], v12 offset:23552
    v_mfma_f32_16x16x32_bf16 v[68:71], v[164:167], v[188:191], v[68:71]
    v_mfma_f32_16x16x32_bf16 v[88:91], v[160:163], v[192:195], v[88:91]
    v_mfma_f32_16x16x32_bf16 v[92:95], v[164:167], v[192:195], v[92:95]
    v_mfma_f32_16x16x32_bf16 v[112:115], v[160:163], v[196:199], v[112:115]
    v_mfma_f32_16x16x32_bf16 v[116:119], v[164:167], v[196:199], v[116:119]
    s_waitcnt lgkmcnt(0)
    s_barrier
    v_mfma_f32_16x16x32_bf16 v[24:27], v[120:123], v[168:171], v[24:27]
    ds_read_b128 v[184:187], v12 offset:40960
    v_mfma_f32_16x16x32_bf16 v[28:31], v[124:127], v[168:171], v[28:31]
    v_mfma_f32_16x16x32_bf16 v[48:51], v[120:123], v[172:175], v[48:51]
    ds_read_b128 v[144:147], v11 offset:40960
    v_mfma_f32_16x16x32_bf16 v[52:55], v[124:127], v[172:175], v[52:55]
    v_mfma_f32_16x16x32_bf16 v[72:75], v[120:123], v[176:179], v[72:75]
    ds_read_b128 v[148:151], v11 offset:41984
    v_mfma_f32_16x16x32_bf16 v[76:79], v[124:127], v[176:179], v[76:79]
    v_mfma_f32_16x16x32_bf16 v[96:99], v[120:123], v[180:183], v[96:99]
    ds_read_b128 v[188:191], v12 offset:41984
    v_mfma_f32_16x16x32_bf16 v[100:103], v[124:127], v[180:183], v[100:103]
    v_mfma_f32_16x16x32_bf16 v[32:35], v[128:131], v[168:171], v[32:35]
    ds_read_b128 v[152:155], v11 offset:43008
    v_mfma_f32_16x16x32_bf16 v[36:39], v[132:135], v[168:171], v[36:39]
    v_mfma_f32_16x16x32_bf16 v[56:59], v[128:131], v[172:175], v[56:59]
    ds_read_b128 v[156:159], v11 offset:44032
    v_mfma_f32_16x16x32_bf16 v[60:63], v[132:135], v[172:175], v[60:63]
    v_mfma_f32_16x16x32_bf16 v[80:83], v[128:131], v[176:179], v[80:83]
    ds_read_b128 v[192:195], v12 offset:43008
    v_mfma_f32_16x16x32_bf16 v[84:87], v[132:135], v[176:179], v[84:87]
    v_mfma_f32_16x16x32_bf16 v[104:107], v[128:131], v[180:183], v[104:107]
    ds_read_b128 v[160:163], v11 offset:45056
    v_mfma_f32_16x16x32_bf16 v[108:111], v[132:135], v[180:183], v[108:111]
    v_mfma_f32_16x16x32_bf16 v[40:43], v[136:139], v[168:171], v[40:43]
    ds_read_b128 v[164:167], v11 offset:46080
    v_mfma_f32_16x16x32_bf16 v[44:47], v[140:143], v[168:171], v[44:47]
    v_mfma_f32_16x16x32_bf16 v[64:67], v[136:139], v[172:175], v[64:67]
    ds_read_b128 v[196:199], v12 offset:44032
    v_mfma_f32_16x16x32_bf16 v[68:71], v[140:143], v[172:175], v[68:71]
    v_mfma_f32_16x16x32_bf16 v[88:91], v[136:139], v[176:179], v[88:91]
    v_mfma_f32_16x16x32_bf16 v[92:95], v[140:143], v[176:179], v[92:95]
    v_mfma_f32_16x16x32_bf16 v[112:115], v[136:139], v[180:183], v[112:115]
    v_mfma_f32_16x16x32_bf16 v[116:119], v[140:143], v[180:183], v[116:119]
    s_waitcnt lgkmcnt(0)
    s_barrier
    v_mfma_f32_16x16x32_bf16 v[24:27], v[144:147], v[184:187], v[24:27]
    ds_read_b128 v[168:171], v18 offset:0
    v_mfma_f32_16x16x32_bf16 v[28:31], v[148:151], v[184:187], v[28:31]
    v_mfma_f32_16x16x32_bf16 v[48:51], v[144:147], v[188:191], v[48:51]
    ds_read_b128 v[120:123], v13 offset:0
    v_mfma_f32_16x16x32_bf16 v[52:55], v[148:151], v[188:191], v[52:55]
    v_mfma_f32_16x16x32_bf16 v[72:75], v[144:147], v[192:195], v[72:75]
    ds_read_b128 v[124:127], v13 offset:1024
    v_mfma_f32_16x16x32_bf16 v[76:79], v[148:151], v[192:195], v[76:79]
    v_mfma_f32_16x16x32_bf16 v[96:99], v[144:147], v[196:199], v[96:99]
    ds_read_b128 v[172:175], v18 offset:1024
    v_mfma_f32_16x16x32_bf16 v[100:103], v[148:151], v[196:199], v[100:103]
    v_mfma_f32_16x16x32_bf16 v[32:35], v[152:155], v[184:187], v[32:35]
    ds_read_b128 v[128:131], v13 offset:2048
    v_mfma_f32_16x16x32_bf16 v[36:39], v[156:159], v[184:187], v[36:39]
    v_mfma_f32_16x16x32_bf16 v[56:59], v[152:155], v[188:191], v[56:59]
    ds_read_b128 v[132:135], v13 offset:3072
    v_mfma_f32_16x16x32_bf16 v[60:63], v[156:159], v[188:191], v[60:63]
    v_mfma_f32_16x16x32_bf16 v[80:83], v[152:155], v[192:195], v[80:83]
    ds_read_b128 v[176:179], v18 offset:2048
    v_mfma_f32_16x16x32_bf16 v[84:87], v[156:159], v[192:195], v[84:87]
    v_mfma_f32_16x16x32_bf16 v[104:107], v[152:155], v[196:199], v[104:107]
    ds_read_b128 v[136:139], v13 offset:4096
    v_mfma_f32_16x16x32_bf16 v[108:111], v[156:159], v[196:199], v[108:111]
    v_mfma_f32_16x16x32_bf16 v[40:43], v[160:163], v[184:187], v[40:43]
    ds_read_b128 v[140:143], v13 offset:5120
    v_mfma_f32_16x16x32_bf16 v[44:47], v[164:167], v[184:187], v[44:47]
    v_mfma_f32_16x16x32_bf16 v[64:67], v[160:163], v[188:191], v[64:67]
    ds_read_b128 v[180:183], v18 offset:3072
    v_mfma_f32_16x16x32_bf16 v[68:71], v[164:167], v[188:191], v[68:71]
    v_mfma_f32_16x16x32_bf16 v[88:91], v[160:163], v[192:195], v[88:91]
    v_mfma_f32_16x16x32_bf16 v[92:95], v[164:167], v[192:195], v[92:95]
    v_mfma_f32_16x16x32_bf16 v[112:115], v[160:163], v[196:199], v[112:115]
    v_mfma_f32_16x16x32_bf16 v[116:119], v[164:167], v[196:199], v[116:119]
    s_waitcnt lgkmcnt(0)
    s_barrier
    v_mfma_f32_16x16x32_bf16 v[24:27], v[120:123], v[168:171], v[24:27]
    ds_read_b128 v[184:187], v18 offset:20480
    v_mfma_f32_16x16x32_bf16 v[28:31], v[124:127], v[168:171], v[28:31]
    v_mfma_f32_16x16x32_bf16 v[48:51], v[120:123], v[172:175], v[48:51]
    ds_read_b128 v[144:147], v13 offset:20480
    v_mfma_f32_16x16x32_bf16 v[52:55], v[124:127], v[172:175], v[52:55]
    v_mfma_f32_16x16x32_bf16 v[72:75], v[120:123], v[176:179], v[72:75]
    ds_read_b128 v[148:151], v13 offset:21504
    v_mfma_f32_16x16x32_bf16 v[76:79], v[124:127], v[176:179], v[76:79]
    v_mfma_f32_16x16x32_bf16 v[96:99], v[120:123], v[180:183], v[96:99]
    ds_read_b128 v[188:191], v18 offset:21504
    v_mfma_f32_16x16x32_bf16 v[100:103], v[124:127], v[180:183], v[100:103]
    v_mfma_f32_16x16x32_bf16 v[32:35], v[128:131], v[168:171], v[32:35]
    ds_read_b128 v[152:155], v13 offset:22528
    v_mfma_f32_16x16x32_bf16 v[36:39], v[132:135], v[168:171], v[36:39]
    v_mfma_f32_16x16x32_bf16 v[56:59], v[128:131], v[172:175], v[56:59]
    ds_read_b128 v[156:159], v13 offset:23552
    v_mfma_f32_16x16x32_bf16 v[60:63], v[132:135], v[172:175], v[60:63]
    v_mfma_f32_16x16x32_bf16 v[80:83], v[128:131], v[176:179], v[80:83]
    ds_read_b128 v[192:195], v18 offset:22528
    v_mfma_f32_16x16x32_bf16 v[84:87], v[132:135], v[176:179], v[84:87]
    v_mfma_f32_16x16x32_bf16 v[104:107], v[128:131], v[180:183], v[104:107]
    ds_read_b128 v[160:163], v13 offset:24576
    v_mfma_f32_16x16x32_bf16 v[108:111], v[132:135], v[180:183], v[108:111]
    v_mfma_f32_16x16x32_bf16 v[40:43], v[136:139], v[168:171], v[40:43]
    ds_read_b128 v[164:167], v13 offset:25600
    v_mfma_f32_16x16x32_bf16 v[44:47], v[140:143], v[168:171], v[44:47]
    v_mfma_f32_16x16x32_bf16 v[64:67], v[136:139], v[172:175], v[64:67]
    ds_read_b128 v[196:199], v18 offset:23552
    v_mfma_f32_16x16x32_bf16 v[68:71], v[140:143], v[172:175], v[68:71]
    v_mfma_f32_16x16x32_bf16 v[88:91], v[136:139], v[176:179], v[88:91]
    v_mfma_f32_16x16x32_bf16 v[92:95], v[140:143], v[176:179], v[92:95]
    v_mfma_f32_16x16x32_bf16 v[112:115], v[136:139], v[180:183], v[112:115]
    v_mfma_f32_16x16x32_bf16 v[116:119], v[140:143], v[180:183], v[116:119]
    s_waitcnt lgkmcnt(0)
    s_barrier
    v_mfma_f32_16x16x32_bf16 v[24:27], v[144:147], v[184:187], v[24:27]
    ds_read_b128 v[168:171], v18 offset:40960
    v_mfma_f32_16x16x32_bf16 v[28:31], v[148:151], v[184:187], v[28:31]
    v_mfma_f32_16x16x32_bf16 v[48:51], v[144:147], v[188:191], v[48:51]
    ds_read_b128 v[120:123], v13 offset:40960
    v_mfma_f32_16x16x32_bf16 v[52:55], v[148:151], v[188:191], v[52:55]
    v_mfma_f32_16x16x32_bf16 v[72:75], v[144:147], v[192:195], v[72:75]
    ds_read_b128 v[124:127], v13 offset:41984
    v_mfma_f32_16x16x32_bf16 v[76:79], v[148:151], v[192:195], v[76:79]
    v_mfma_f32_16x16x32_bf16 v[96:99], v[144:147], v[196:199], v[96:99]
    ds_read_b128 v[172:175], v18 offset:41984
    v_mfma_f32_16x16x32_bf16 v[100:103], v[148:151], v[196:199], v[100:103]
    v_mfma_f32_16x16x32_bf16 v[32:35], v[152:155], v[184:187], v[32:35]
    ds_read_b128 v[128:131], v13 offset:43008
    v_mfma_f32_16x16x32_bf16 v[36:39], v[156:159], v[184:187], v[36:39]
    v_mfma_f32_16x16x32_bf16 v[56:59], v[152:155], v[188:191], v[56:59]
    ds_read_b128 v[132:135], v13 offset:44032
    v_mfma_f32_16x16x32_bf16 v[60:63], v[156:159], v[188:191], v[60:63]
    v_mfma_f32_16x16x32_bf16 v[80:83], v[152:155], v[192:195], v[80:83]
    ds_read_b128 v[176:179], v18 offset:43008
    v_mfma_f32_16x16x32_bf16 v[84:87], v[156:159], v[192:195], v[84:87]
    v_mfma_f32_16x16x32_bf16 v[104:107], v[152:155], v[196:199], v[104:107]
    ds_read_b128 v[136:139], v13 offset:45056
    v_mfma_f32_16x16x32_bf16 v[108:111], v[156:159], v[196:199], v[108:111]
    v_mfma_f32_16x16x32_bf16 v[40:43], v[160:163], v[184:187], v[40:43]
    ds_read_b128 v[140:143], v13 offset:46080
    v_mfma_f32_16x16x32_bf16 v[44:47], v[164:167], v[184:187], v[44:47]
    v_mfma_f32_16x16x32_bf16 v[64:67], v[160:163], v[188:191], v[64:67]
    ds_read_b128 v[180:183], v18 offset:44032
    v_mfma_f32_16x16x32_bf16 v[68:71], v[164:167], v[188:191], v[68:71]
    v_mfma_f32_16x16x32_bf16 v[88:91], v[160:163], v[192:195], v[88:91]
    v_mfma_f32_16x16x32_bf16 v[92:95], v[164:167], v[192:195], v[92:95]
    v_mfma_f32_16x16x32_bf16 v[112:115], v[160:163], v[196:199], v[112:115]
    v_mfma_f32_16x16x32_bf16 v[116:119], v[164:167], v[196:199], v[116:119]
    s_waitcnt lgkmcnt(0)
    s_barrier
    v_mfma_f32_16x16x32_bf16 v[24:27], v[120:123], v[168:171], v[24:27]
    ds_read_b128 v[184:187], v19 offset:0
    v_mfma_f32_16x16x32_bf16 v[28:31], v[124:127], v[168:171], v[28:31]
    v_mfma_f32_16x16x32_bf16 v[48:51], v[120:123], v[172:175], v[48:51]
    ds_read_b128 v[144:147], v17 offset:0
    v_mfma_f32_16x16x32_bf16 v[52:55], v[124:127], v[172:175], v[52:55]
    v_mfma_f32_16x16x32_bf16 v[72:75], v[120:123], v[176:179], v[72:75]
    ds_read_b128 v[148:151], v17 offset:1024
    v_mfma_f32_16x16x32_bf16 v[76:79], v[124:127], v[176:179], v[76:79]
    v_mfma_f32_16x16x32_bf16 v[96:99], v[120:123], v[180:183], v[96:99]
    ds_read_b128 v[188:191], v19 offset:1024
    v_mfma_f32_16x16x32_bf16 v[100:103], v[124:127], v[180:183], v[100:103]
    v_mfma_f32_16x16x32_bf16 v[32:35], v[128:131], v[168:171], v[32:35]
    ds_read_b128 v[152:155], v17 offset:2048
    v_mfma_f32_16x16x32_bf16 v[36:39], v[132:135], v[168:171], v[36:39]
    v_mfma_f32_16x16x32_bf16 v[56:59], v[128:131], v[172:175], v[56:59]
    ds_read_b128 v[156:159], v17 offset:3072
    v_mfma_f32_16x16x32_bf16 v[60:63], v[132:135], v[172:175], v[60:63]
    v_mfma_f32_16x16x32_bf16 v[80:83], v[128:131], v[176:179], v[80:83]
    ds_read_b128 v[192:195], v19 offset:2048
    v_mfma_f32_16x16x32_bf16 v[84:87], v[132:135], v[176:179], v[84:87]
    v_mfma_f32_16x16x32_bf16 v[104:107], v[128:131], v[180:183], v[104:107]
    ds_read_b128 v[160:163], v17 offset:4096
    v_mfma_f32_16x16x32_bf16 v[108:111], v[132:135], v[180:183], v[108:111]
    v_mfma_f32_16x16x32_bf16 v[40:43], v[136:139], v[168:171], v[40:43]
    ds_read_b128 v[164:167], v17 offset:5120
    v_mfma_f32_16x16x32_bf16 v[44:47], v[140:143], v[168:171], v[44:47]
    v_mfma_f32_16x16x32_bf16 v[64:67], v[136:139], v[172:175], v[64:67]
    ds_read_b128 v[196:199], v19 offset:3072
    v_mfma_f32_16x16x32_bf16 v[68:71], v[140:143], v[172:175], v[68:71]
    v_mfma_f32_16x16x32_bf16 v[88:91], v[136:139], v[176:179], v[88:91]
    v_mfma_f32_16x16x32_bf16 v[92:95], v[140:143], v[176:179], v[92:95]
    v_mfma_f32_16x16x32_bf16 v[112:115], v[136:139], v[180:183], v[112:115]
    v_mfma_f32_16x16x32_bf16 v[116:119], v[140:143], v[180:183], v[116:119]
    s_waitcnt lgkmcnt(0)
    s_barrier
    v_mfma_f32_16x16x32_bf16 v[24:27], v[144:147], v[184:187], v[24:27]
    ds_read_b128 v[168:171], v12 offset:0
    v_mfma_f32_16x16x32_bf16 v[28:31], v[148:151], v[184:187], v[28:31]
    v_mfma_f32_16x16x32_bf16 v[48:51], v[144:147], v[188:191], v[48:51]
    ds_read_b128 v[120:123], v11 offset:0
    v_mfma_f32_16x16x32_bf16 v[52:55], v[148:151], v[188:191], v[52:55]
    v_mfma_f32_16x16x32_bf16 v[72:75], v[144:147], v[192:195], v[72:75]
    ds_read_b128 v[124:127], v11 offset:1024
    v_mfma_f32_16x16x32_bf16 v[76:79], v[148:151], v[192:195], v[76:79]
    v_mfma_f32_16x16x32_bf16 v[96:99], v[144:147], v[196:199], v[96:99]
    ds_read_b128 v[172:175], v12 offset:1024
    v_mfma_f32_16x16x32_bf16 v[100:103], v[148:151], v[196:199], v[100:103]
    v_mfma_f32_16x16x32_bf16 v[32:35], v[152:155], v[184:187], v[32:35]
    ds_read_b128 v[128:131], v11 offset:2048
    v_mfma_f32_16x16x32_bf16 v[36:39], v[156:159], v[184:187], v[36:39]
    v_mfma_f32_16x16x32_bf16 v[56:59], v[152:155], v[188:191], v[56:59]
    ds_read_b128 v[132:135], v11 offset:3072
    v_mfma_f32_16x16x32_bf16 v[60:63], v[156:159], v[188:191], v[60:63]
    v_mfma_f32_16x16x32_bf16 v[80:83], v[152:155], v[192:195], v[80:83]
    ds_read_b128 v[176:179], v12 offset:2048
    v_mfma_f32_16x16x32_bf16 v[84:87], v[156:159], v[192:195], v[84:87]
    v_mfma_f32_16x16x32_bf16 v[104:107], v[152:155], v[196:199], v[104:107]
    ds_read_b128 v[136:139], v11 offset:4096
    v_mfma_f32_16x16x32_bf16 v[108:111], v[156:159], v[196:199], v[108:111]
    v_mfma_f32_16x16x32_bf16 v[40:43], v[160:163], v[184:187], v[40:43]
    ds_read_b128 v[140:143], v11 offset:5120
    v_mfma_f32_16x16x32_bf16 v[44:47], v[164:167], v[184:187], v[44:47]
    v_mfma_f32_16x16x32_bf16 v[64:67], v[160:163], v[188:191], v[64:67]
    ds_read_b128 v[180:183], v12 offset:3072
    v_mfma_f32_16x16x32_bf16 v[68:71], v[164:167], v[188:191], v[68:71]
    v_mfma_f32_16x16x32_bf16 v[88:91], v[160:163], v[192:195], v[88:91]
    v_mfma_f32_16x16x32_bf16 v[92:95], v[164:167], v[192:195], v[92:95]
    v_mfma_f32_16x16x32_bf16 v[112:115], v[160:163], v[196:199], v[112:115]
    v_mfma_f32_16x16x32_bf16 v[116:119], v[164:167], v[196:199], v[116:119]
    s_waitcnt lgkmcnt(0)
    s_barrier
    v_mfma_f32_16x16x32_bf16 v[24:27], v[120:123], v[168:171], v[24:27]
    ds_read_b128 v[184:187], v12 offset:20480
    v_mfma_f32_16x16x32_bf16 v[28:31], v[124:127], v[168:171], v[28:31]
    v_mfma_f32_16x16x32_bf16 v[48:51], v[120:123], v[172:175], v[48:51]
    ds_read_b128 v[144:147], v11 offset:20480
    v_mfma_f32_16x16x32_bf16 v[52:55], v[124:127], v[172:175], v[52:55]
    v_mfma_f32_16x16x32_bf16 v[72:75], v[120:123], v[176:179], v[72:75]
    ds_read_b128 v[148:151], v11 offset:21504
    v_mfma_f32_16x16x32_bf16 v[76:79], v[124:127], v[176:179], v[76:79]
    v_mfma_f32_16x16x32_bf16 v[96:99], v[120:123], v[180:183], v[96:99]
    ds_read_b128 v[188:191], v12 offset:21504
    v_mfma_f32_16x16x32_bf16 v[100:103], v[124:127], v[180:183], v[100:103]
    v_mfma_f32_16x16x32_bf16 v[32:35], v[128:131], v[168:171], v[32:35]
    ds_read_b128 v[152:155], v11 offset:22528
    v_mfma_f32_16x16x32_bf16 v[36:39], v[132:135], v[168:171], v[36:39]
    v_mfma_f32_16x16x32_bf16 v[56:59], v[128:131], v[172:175], v[56:59]
    ds_read_b128 v[156:159], v11 offset:23552
    v_mfma_f32_16x16x32_bf16 v[60:63], v[132:135], v[172:175], v[60:63]
    v_mfma_f32_16x16x32_bf16 v[80:83], v[128:131], v[176:179], v[80:83]
    ds_read_b128 v[192:195], v12 offset:22528
    v_mfma_f32_16x16x32_bf16 v[84:87], v[132:135], v[176:179], v[84:87]
    v_mfma_f32_16x16x32_bf16 v[104:107], v[128:131], v[180:183], v[104:107]
    ds_read_b128 v[160:163], v11 offset:24576
    v_mfma_f32_16x16x32_bf16 v[108:111], v[132:135], v[180:183], v[108:111]
    v_mfma_f32_16x16x32_bf16 v[40:43], v[136:139], v[168:171], v[40:43]
    ds_read_b128 v[164:167], v11 offset:25600
    v_mfma_f32_16x16x32_bf16 v[44:47], v[140:143], v[168:171], v[44:47]
    v_mfma_f32_16x16x32_bf16 v[64:67], v[136:139], v[172:175], v[64:67]
    ds_read_b128 v[196:199], v12 offset:23552
    v_mfma_f32_16x16x32_bf16 v[68:71], v[140:143], v[172:175], v[68:71]
    v_mfma_f32_16x16x32_bf16 v[88:91], v[136:139], v[176:179], v[88:91]
    v_mfma_f32_16x16x32_bf16 v[92:95], v[140:143], v[176:179], v[92:95]
    v_mfma_f32_16x16x32_bf16 v[112:115], v[136:139], v[180:183], v[112:115]
    v_mfma_f32_16x16x32_bf16 v[116:119], v[140:143], v[180:183], v[116:119]
    s_waitcnt lgkmcnt(0)
    s_barrier
    v_mfma_f32_16x16x32_bf16 v[24:27], v[144:147], v[184:187], v[24:27]
    ds_read_b128 v[168:171], v12 offset:40960
    v_mfma_f32_16x16x32_bf16 v[28:31], v[148:151], v[184:187], v[28:31]
    v_mfma_f32_16x16x32_bf16 v[48:51], v[144:147], v[188:191], v[48:51]
    ds_read_b128 v[120:123], v11 offset:40960
    v_mfma_f32_16x16x32_bf16 v[52:55], v[148:151], v[188:191], v[52:55]
    v_mfma_f32_16x16x32_bf16 v[72:75], v[144:147], v[192:195], v[72:75]
    ds_read_b128 v[124:127], v11 offset:41984
    v_mfma_f32_16x16x32_bf16 v[76:79], v[148:151], v[192:195], v[76:79]
    v_mfma_f32_16x16x32_bf16 v[96:99], v[144:147], v[196:199], v[96:99]
    ds_read_b128 v[172:175], v12 offset:41984
    v_mfma_f32_16x16x32_bf16 v[100:103], v[148:151], v[196:199], v[100:103]
    v_mfma_f32_16x16x32_bf16 v[32:35], v[152:155], v[184:187], v[32:35]
    ds_read_b128 v[128:131], v11 offset:43008
    v_mfma_f32_16x16x32_bf16 v[36:39], v[156:159], v[184:187], v[36:39]
    v_mfma_f32_16x16x32_bf16 v[56:59], v[152:155], v[188:191], v[56:59]
    ds_read_b128 v[132:135], v11 offset:44032
    v_mfma_f32_16x16x32_bf16 v[60:63], v[156:159], v[188:191], v[60:63]
    v_mfma_f32_16x16x32_bf16 v[80:83], v[152:155], v[192:195], v[80:83]
    ds_read_b128 v[176:179], v12 offset:43008
    v_mfma_f32_16x16x32_bf16 v[84:87], v[156:159], v[192:195], v[84:87]
    v_mfma_f32_16x16x32_bf16 v[104:107], v[152:155], v[196:199], v[104:107]
    ds_read_b128 v[136:139], v11 offset:45056
    v_mfma_f32_16x16x32_bf16 v[108:111], v[156:159], v[196:199], v[108:111]
    v_mfma_f32_16x16x32_bf16 v[40:43], v[160:163], v[184:187], v[40:43]
    ds_read_b128 v[140:143], v11 offset:46080
    v_mfma_f32_16x16x32_bf16 v[44:47], v[164:167], v[184:187], v[44:47]
    v_mfma_f32_16x16x32_bf16 v[64:67], v[160:163], v[188:191], v[64:67]
    ds_read_b128 v[180:183], v12 offset:44032
    v_mfma_f32_16x16x32_bf16 v[68:71], v[164:167], v[188:191], v[68:71]
    v_mfma_f32_16x16x32_bf16 v[88:91], v[160:163], v[192:195], v[88:91]
    v_mfma_f32_16x16x32_bf16 v[92:95], v[164:167], v[192:195], v[92:95]
    v_mfma_f32_16x16x32_bf16 v[112:115], v[160:163], v[196:199], v[112:115]
    v_mfma_f32_16x16x32_bf16 v[116:119], v[164:167], v[196:199], v[116:119]
    s_waitcnt lgkmcnt(0)
    s_barrier
    v_mfma_f32_16x16x32_bf16 v[24:27], v[120:123], v[168:171], v[24:27]
    ds_read_b128 v[184:187], v18 offset:0
    v_mfma_f32_16x16x32_bf16 v[28:31], v[124:127], v[168:171], v[28:31]
    v_mfma_f32_16x16x32_bf16 v[48:51], v[120:123], v[172:175], v[48:51]
    ds_read_b128 v[144:147], v13 offset:0
    v_mfma_f32_16x16x32_bf16 v[52:55], v[124:127], v[172:175], v[52:55]
    v_mfma_f32_16x16x32_bf16 v[72:75], v[120:123], v[176:179], v[72:75]
    ds_read_b128 v[148:151], v13 offset:1024
    v_mfma_f32_16x16x32_bf16 v[76:79], v[124:127], v[176:179], v[76:79]
    v_mfma_f32_16x16x32_bf16 v[96:99], v[120:123], v[180:183], v[96:99]
    ds_read_b128 v[188:191], v18 offset:1024
    v_mfma_f32_16x16x32_bf16 v[100:103], v[124:127], v[180:183], v[100:103]
    v_mfma_f32_16x16x32_bf16 v[32:35], v[128:131], v[168:171], v[32:35]
    ds_read_b128 v[152:155], v13 offset:2048
    v_mfma_f32_16x16x32_bf16 v[36:39], v[132:135], v[168:171], v[36:39]
    v_mfma_f32_16x16x32_bf16 v[56:59], v[128:131], v[172:175], v[56:59]
    ds_read_b128 v[156:159], v13 offset:3072
    v_mfma_f32_16x16x32_bf16 v[60:63], v[132:135], v[172:175], v[60:63]
    v_mfma_f32_16x16x32_bf16 v[80:83], v[128:131], v[176:179], v[80:83]
    ds_read_b128 v[192:195], v18 offset:2048
    v_mfma_f32_16x16x32_bf16 v[84:87], v[132:135], v[176:179], v[84:87]
    v_mfma_f32_16x16x32_bf16 v[104:107], v[128:131], v[180:183], v[104:107]
    ds_read_b128 v[160:163], v13 offset:4096
    v_mfma_f32_16x16x32_bf16 v[108:111], v[132:135], v[180:183], v[108:111]
    v_mfma_f32_16x16x32_bf16 v[40:43], v[136:139], v[168:171], v[40:43]
    ds_read_b128 v[164:167], v13 offset:5120
    v_mfma_f32_16x16x32_bf16 v[44:47], v[140:143], v[168:171], v[44:47]
    v_mfma_f32_16x16x32_bf16 v[64:67], v[136:139], v[172:175], v[64:67]
    ds_read_b128 v[196:199], v18 offset:3072
    v_mfma_f32_16x16x32_bf16 v[68:71], v[140:143], v[172:175], v[68:71]
    v_mfma_f32_16x16x32_bf16 v[88:91], v[136:139], v[176:179], v[88:91]
    v_mfma_f32_16x16x32_bf16 v[92:95], v[140:143], v[176:179], v[92:95]
    v_mfma_f32_16x16x32_bf16 v[112:115], v[136:139], v[180:183], v[112:115]
    v_mfma_f32_16x16x32_bf16 v[116:119], v[140:143], v[180:183], v[116:119]
    s_waitcnt lgkmcnt(0)
    s_barrier
    v_mfma_f32_16x16x32_bf16 v[24:27], v[144:147], v[184:187], v[24:27]
    ds_read_b128 v[168:171], v18 offset:20480
    v_mfma_f32_16x16x32_bf16 v[28:31], v[148:151], v[184:187], v[28:31]
    v_mfma_f32_16x16x32_bf16 v[48:51], v[144:147], v[188:191], v[48:51]
    ds_read_b128 v[120:123], v13 offset:20480
    v_mfma_f32_16x16x32_bf16 v[52:55], v[148:151], v[188:191], v[52:55]
    v_mfma_f32_16x16x32_bf16 v[72:75], v[144:147], v[192:195], v[72:75]
    ds_read_b128 v[124:127], v13 offset:21504
    v_mfma_f32_16x16x32_bf16 v[76:79], v[148:151], v[192:195], v[76:79]
    v_mfma_f32_16x16x32_bf16 v[96:99], v[144:147], v[196:199], v[96:99]
    ds_read_b128 v[172:175], v18 offset:21504
    v_mfma_f32_16x16x32_bf16 v[100:103], v[148:151], v[196:199], v[100:103]
    v_mfma_f32_16x16x32_bf16 v[32:35], v[152:155], v[184:187], v[32:35]
    ds_read_b128 v[128:131], v13 offset:22528
    v_mfma_f32_16x16x32_bf16 v[36:39], v[156:159], v[184:187], v[36:39]
    v_mfma_f32_16x16x32_bf16 v[56:59], v[152:155], v[188:191], v[56:59]
    ds_read_b128 v[132:135], v13 offset:23552
    v_mfma_f32_16x16x32_bf16 v[60:63], v[156:159], v[188:191], v[60:63]
    v_mfma_f32_16x16x32_bf16 v[80:83], v[152:155], v[192:195], v[80:83]
    ds_read_b128 v[176:179], v18 offset:22528
    v_mfma_f32_16x16x32_bf16 v[84:87], v[156:159], v[192:195], v[84:87]
    v_mfma_f32_16x16x32_bf16 v[104:107], v[152:155], v[196:199], v[104:107]
    ds_read_b128 v[136:139], v13 offset:24576
    v_mfma_f32_16x16x32_bf16 v[108:111], v[156:159], v[196:199], v[108:111]
    v_mfma_f32_16x16x32_bf16 v[40:43], v[160:163], v[184:187], v[40:43]
    ds_read_b128 v[140:143], v13 offset:25600
    v_mfma_f32_16x16x32_bf16 v[44:47], v[164:167], v[184:187], v[44:47]
    v_mfma_f32_16x16x32_bf16 v[64:67], v[160:163], v[188:191], v[64:67]
    ds_read_b128 v[180:183], v18 offset:23552
    v_mfma_f32_16x16x32_bf16 v[68:71], v[164:167], v[188:191], v[68:71]
    v_mfma_f32_16x16x32_bf16 v[88:91], v[160:163], v[192:195], v[88:91]
    v_mfma_f32_16x16x32_bf16 v[92:95], v[164:167], v[192:195], v[92:95]
    v_mfma_f32_16x16x32_bf16 v[112:115], v[160:163], v[196:199], v[112:115]
    v_mfma_f32_16x16x32_bf16 v[116:119], v[164:167], v[196:199], v[116:119]
    s_waitcnt lgkmcnt(0)
    s_barrier
    v_mfma_f32_16x16x32_bf16 v[24:27], v[120:123], v[168:171], v[24:27]
    ds_read_b128 v[184:187], v18 offset:40960
    v_mfma_f32_16x16x32_bf16 v[28:31], v[124:127], v[168:171], v[28:31]
    v_mfma_f32_16x16x32_bf16 v[48:51], v[120:123], v[172:175], v[48:51]
    ds_read_b128 v[144:147], v13 offset:40960
    v_mfma_f32_16x16x32_bf16 v[52:55], v[124:127], v[172:175], v[52:55]
    v_mfma_f32_16x16x32_bf16 v[72:75], v[120:123], v[176:179], v[72:75]
    ds_read_b128 v[148:151], v13 offset:41984
    v_mfma_f32_16x16x32_bf16 v[76:79], v[124:127], v[176:179], v[76:79]
    v_mfma_f32_16x16x32_bf16 v[96:99], v[120:123], v[180:183], v[96:99]
    ds_read_b128 v[188:191], v18 offset:41984
    v_mfma_f32_16x16x32_bf16 v[100:103], v[124:127], v[180:183], v[100:103]
    v_mfma_f32_16x16x32_bf16 v[32:35], v[128:131], v[168:171], v[32:35]
    ds_read_b128 v[152:155], v13 offset:43008
    v_mfma_f32_16x16x32_bf16 v[36:39], v[132:135], v[168:171], v[36:39]
    v_mfma_f32_16x16x32_bf16 v[56:59], v[128:131], v[172:175], v[56:59]
    ds_read_b128 v[156:159], v13 offset:44032
    v_mfma_f32_16x16x32_bf16 v[60:63], v[132:135], v[172:175], v[60:63]
    v_mfma_f32_16x16x32_bf16 v[80:83], v[128:131], v[176:179], v[80:83]
    ds_read_b128 v[192:195], v18 offset:43008
    v_mfma_f32_16x16x32_bf16 v[84:87], v[132:135], v[176:179], v[84:87]
    v_mfma_f32_16x16x32_bf16 v[104:107], v[128:131], v[180:183], v[104:107]
    ds_read_b128 v[160:163], v13 offset:45056
    v_mfma_f32_16x16x32_bf16 v[108:111], v[132:135], v[180:183], v[108:111]
    v_mfma_f32_16x16x32_bf16 v[40:43], v[136:139], v[168:171], v[40:43]
    ds_read_b128 v[164:167], v13 offset:46080
    v_mfma_f32_16x16x32_bf16 v[44:47], v[140:143], v[168:171], v[44:47]
    v_mfma_f32_16x16x32_bf16 v[64:67], v[136:139], v[172:175], v[64:67]
    ds_read_b128 v[196:199], v18 offset:44032
    v_mfma_f32_16x16x32_bf16 v[68:71], v[140:143], v[172:175], v[68:71]
    v_mfma_f32_16x16x32_bf16 v[88:91], v[136:139], v[176:179], v[88:91]
    v_mfma_f32_16x16x32_bf16 v[92:95], v[140:143], v[176:179], v[92:95]
    v_mfma_f32_16x16x32_bf16 v[112:115], v[136:139], v[180:183], v[112:115]
    v_mfma_f32_16x16x32_bf16 v[116:119], v[140:143], v[180:183], v[116:119]
    s_waitcnt lgkmcnt(0)
    v_mfma_f32_16x16x32_bf16 v[24:27], v[144:147], v[184:187], v[24:27]
    v_mfma_f32_16x16x32_bf16 v[28:31], v[148:151], v[184:187], v[28:31]
    v_mfma_f32_16x16x32_bf16 v[48:51], v[144:147], v[188:191], v[48:51]
    v_mfma_f32_16x16x32_bf16 v[52:55], v[148:151], v[188:191], v[52:55]
    v_mfma_f32_16x16x32_bf16 v[72:75], v[144:147], v[192:195], v[72:75]
    v_mfma_f32_16x16x32_bf16 v[76:79], v[148:151], v[192:195], v[76:79]
    v_mfma_f32_16x16x32_bf16 v[96:99], v[144:147], v[196:199], v[96:99]
    v_mfma_f32_16x16x32_bf16 v[100:103], v[148:151], v[196:199], v[100:103]
    v_mfma_f32_16x16x32_bf16 v[32:35], v[152:155], v[184:187], v[32:35]
    v_mfma_f32_16x16x32_bf16 v[36:39], v[156:159], v[184:187], v[36:39]
    v_mfma_f32_16x16x32_bf16 v[56:59], v[152:155], v[188:191], v[56:59]
    v_mfma_f32_16x16x32_bf16 v[60:63], v[156:159], v[188:191], v[60:63]
    v_mfma_f32_16x16x32_bf16 v[80:83], v[152:155], v[192:195], v[80:83]
    v_mfma_f32_16x16x32_bf16 v[84:87], v[156:159], v[192:195], v[84:87]
    v_mfma_f32_16x16x32_bf16 v[104:107], v[152:155], v[196:199], v[104:107]
    v_mfma_f32_16x16x32_bf16 v[108:111], v[156:159], v[196:199], v[108:111]
    v_mfma_f32_16x16x32_bf16 v[40:43], v[160:163], v[184:187], v[40:43]
    v_mfma_f32_16x16x32_bf16 v[44:47], v[164:167], v[184:187], v[44:47]
    v_mfma_f32_16x16x32_bf16 v[64:67], v[160:163], v[188:191], v[64:67]
    v_mfma_f32_16x16x32_bf16 v[68:71], v[164:167], v[188:191], v[68:71]
    v_mfma_f32_16x16x32_bf16 v[88:91], v[160:163], v[192:195], v[88:91]
    v_mfma_f32_16x16x32_bf16 v[92:95], v[164:167], v[192:195], v[92:95]
    v_mfma_f32_16x16x32_bf16 v[112:115], v[160:163], v[196:199], v[112:115]
    v_mfma_f32_16x16x32_bf16 v[116:119], v[164:167], v[196:199], v[116:119]
    s_cmp_lt_u32 s2, 16
    s_cbranch_scc0 p4_kernel_pf_skip
    s_getpc_b64 s[60:61]
p4_kernel_pf:
    s_add_u32 s60, s60, p5_kernel-p4_kernel_pf
    s_addc_u32 s61, s61, 0
    v_lshlrev_b32 v14, 7, v0
    v_min_u32 v14, p5_kernel_end-p5_kernel, v14
    v_mov_b32 v15, s61
    v_add_co_u32 v14, vcc, s60, v14
    s_nop 1
    v_addc_co_u32 v15, vcc, 0, v15, vcc
    global_load_dword v16, v[14:15], off
p4_kernel_pf_skip:
    v_cvt_pk_bf16_f32 v120, v24, v28
    v_cvt_pk_bf16_f32 v121, v25, v29
    v_cvt_pk_bf16_f32 v122, v26, v30
    v_cvt_pk_bf16_f32 v123, v27, v31
    ds_write_b128 v20, v[120:123] offset:0
    v_cvt_pk_bf16_f32 v124, v48, v52
    v_cvt_pk_bf16_f32 v125, v49, v53
    v_cvt_pk_bf16_f32 v126, v50, v54
    v_cvt_pk_bf16_f32 v127, v51, v55
    ds_write_b128 v20, v[124:127] offset:6144
    v_cvt_pk_bf16_f32 v120, v72, v76
    v_cvt_pk_bf16_f32 v121, v73, v77
    v_cvt_pk_bf16_f32 v122, v74, v78
    v_cvt_pk_bf16_f32 v123, v75, v79
    ds_write_b128 v20, v[120:123] offset:12288
    v_cvt_pk_bf16_f32 v124, v96, v100
    v_cvt_pk_bf16_f32 v125, v97, v101
    v_cvt_pk_bf16_f32 v126, v98, v102
    v_cvt_pk_bf16_f32 v127, v99, v103
    ds_write_b128 v20, v[124:127] offset:18432
    v_cvt_pk_bf16_f32 v120, v32, v36
    v_cvt_pk_bf16_f32 v121, v33, v37
    v_cvt_pk_bf16_f32 v122, v34, v38
    v_cvt_pk_bf16_f32 v123, v35, v39
    ds_write_b128 v20, v[120:123] offset:1024
    v_cvt_pk_bf16_f32 v124, v56, v60
    v_cvt_pk_bf16_f32 v125, v57, v61
    v_cvt_pk_bf16_f32 v126, v58, v62
    v_cvt_pk_bf16_f32 v127, v59, v63
    ds_write_b128 v20, v[124:127] offset:7168
    v_cvt_pk_bf16_f32 v120, v80, v84
    v_cvt_pk_bf16_f32 v121, v81, v85
    v_cvt_pk_bf16_f32 v122, v82, v86
    v_cvt_pk_bf16_f32 v123, v83, v87
    ds_write_b128 v20, v[120:123] offset:13312
    v_cvt_pk_bf16_f32 v124, v104, v108
    v_cvt_pk_bf16_f32 v125, v105, v109
    v_cvt_pk_bf16_f32 v126, v106, v110
    v_cvt_pk_bf16_f32 v127, v107, v111
    ds_write_b128 v20, v[124:127] offset:19456
    v_cvt_pk_bf16_f32 v120, v40, v44
    v_cvt_pk_bf16_f32 v121, v41, v45
    v_cvt_pk_bf16_f32 v122, v42, v46
    v_cvt_pk_bf16_f32 v123, v43, v47
    ds_write_b128 v20, v[120:123] offset:2048
    v_cvt_pk_bf16_f32 v124, v64, v68
    v_cvt_pk_bf16_f32 v125, v65, v69
    v_cvt_pk_bf16_f32 v126, v66, v70
    v_cvt_pk_bf16_f32 v127, v67, v71
    ds_write_b128 v20, v[124:127] offset:8192
    v_cvt_pk_bf16_f32 v120, v88, v92
    v_cvt_pk_bf16_f32 v121, v89, v93
    v_cvt_pk_bf16_f32 v122, v90, v94
    v_cvt_pk_bf16_f32 v123, v91, v95
    ds_write_b128 v20, v[120:123] offset:14336
    v_cvt_pk_bf16_f32 v124, v112, v116
    v_cvt_pk_bf16_f32 v125, v113, v117
    v_cvt_pk_bf16_f32 v126, v114, v118
    v_cvt_pk_bf16_f32 v127, v115, v119
    ds_write_b128 v20, v[124:127] offset:20480
    s_waitcnt lgkmcnt(0)
p4_epi:
    s_barrier
    ds_read_b128 v[200:203], v8 offset:0
    ds_read_b128 v[204:207], v8 offset:1024
    ds_read_b128 v[208:211], v8 offset:2048
    ds_read_b128 v[212:215], v8 offset:3072
    ds_read_b128 v[216:219], v8 offset:4096
    ds_read_b128 v[220:223], v8 offset:5120
    s_mov_b32 s44, 0xbfb8aa3b
    s_mov_b32 s45, 0xbfb8aa3b
    s_mov_b32 s46, 0x3f800000
    s_mov_b32 s47, 0x3f800000
    s_waitcnt lgkmcnt(4)
    v_lshlrev_b32 v224, 16, v200
    v_lshlrev_b32 v225, 16, v201
    v_lshlrev_b32 v228, 16, v202
    v_lshlrev_b32 v229, 16, v203
    v_pk_mul_f32 v[226:227], v[224:225], s[44:45]
    v_pk_mul_f32 v[230:231], v[228:229], s[44:45]
    v_exp_f32 v226, v226
    v_exp_f32 v227, v227
    v_exp_f32 v230, v230
    v_exp_f32 v231, v231
    v_pk_add_f32 v[226:227], v[226:227], s[46:47]
    v_pk_add_f32 v[230:231], v[230:231], s[46:47]
    v_rcp_f32 v226, v226
    v_rcp_f32 v227, v227
    v_rcp_f32 v230, v230
    v_rcp_f32 v231, v231
    v_pk_mul_f32 v[224:225], v[224:225], v[226:227]
    v_pk_mul_f32 v[228:229], v[228:229], v[230:231]
    v_cvt_pk_bf16_f32 v226, 0, v224
    v_cvt_pk_bf16_f32 v227, 0, v225
    v_cvt_pk_bf16_f32 v230, 0, v228
    v_cvt_pk_bf16_f32 v231, 0, v229
    v_dot2_f32_bf16 v200, v226, v200, 0
    v_dot2_f32_bf16 v201, v227, v201, 0
    v_dot2_f32_bf16 v202, v230, v202, 0
    v_dot2_f32_bf16 v203, v231, v203, 0
    v_lshlrev_b32 v224, 16, v204
    v_lshlrev_b32 v225, 16, v205
    v_lshlrev_b32 v228, 16, v206
    v_lshlrev_b32 v229, 16, v207
    v_cvt_pk_bf16_f32 v232, v200, v201
    v_cvt_pk_bf16_f32 v233, v202, v203
    v_pk_mul_f32 v[226:227], v[224:225], s[44:45]
    v_pk_mul_f32 v[230:231], v[228:229], s[44:45]
    v_exp_f32 v226, v226
    v_exp_f32 v227, v227
    v_exp_f32 v230, v230
    v_exp_f32 v231, v231
    v_pk_add_f32 v[226:227], v[226:227], s[46:47]
    v_pk_add_f32 v[230:231], v[230:231], s[46:47]
    v_rcp_f32 v226, v226
    v_rcp_f32 v227, v227
    v_rcp_f32 v230, v230
    v_rcp_f32 v231, v231
    v_pk_mul_f32 v[224:225], v[224:225], v[226:227]
    v_pk_mul_f32 v[228:229], v[228:229], v[230:231]
    v_cvt_pk_bf16_f32 v226, 0, v224
    v_cvt_pk_bf16_f32 v227, 0, v225
    v_cvt_pk_bf16_f32 v230, 0, v228
    v_cvt_pk_bf16_f32 v231, 0, v229
    v_dot2_f32_bf16 v204, v226, v204, 0
    v_dot2_f32_bf16 v205, v227, v205, 0
    v_dot2_f32_bf16 v206, v230, v206, 0
    v_dot2_f32_bf16 v207, v231, v207, 0
    s_waitcnt lgkmcnt(2)
    v_lshlrev_b32 v224, 16, v208
    v_lshlrev_b32 v225, 16, v209
    v_lshlrev_b32 v228, 16, v210
    v_lshlrev_b32 v229, 16, v211
    v_cvt_pk_bf16_f32 v234, v204, v205
    v_cvt_pk_bf16_f32 v235, v206, v207
    buffer_store_dwordx4 v[232:235], v7, s[20:23], s41 offen offset:0 sc1
    v_pk_mul_f32 v[226:227], v[224:225], s[44:45]
    v_pk_mul_f32 v[230:231], v[228:229], s[44:45]
    v_exp_f32 v226, v226
    v_exp_f32 v227, v227
    v_exp_f32 v230, v230
    v_exp_f32 v231, v231
    v_pk_add_f32 v[226:227], v[226:227], s[46:47]
    v_pk_add_f32 v[230:231], v[230:231], s[46:47]
    v_rcp_f32 v226, v226
    v_rcp_f32 v227, v227
    v_rcp_f32 v230, v230
    v_rcp_f32 v231, v231
    v_pk_mul_f32 v[224:225], v[224:225], v[226:227]
    v_pk_mul_f32 v[228:229], v[228:229], v[230:231]
    v_cvt_pk_bf16_f32 v226, 0, v224
    v_cvt_pk_bf16_f32 v227, 0, v225
    v_cvt_pk_bf16_f32 v230, 0, v228
    v_cvt_pk_bf16_f32 v231, 0, v229
    v_dot2_f32_bf16 v208, v226, v208, 0
    v_dot2_f32_bf16 v209, v227, v209, 0
    v_dot2_f32_bf16 v210, v230, v210, 0
    v_dot2_f32_bf16 v211, v231, v211, 0
    v_lshlrev_b32 v224, 16, v212
    v_lshlrev_b32 v225, 16, v213
    v_lshlrev_b32 v228, 16, v214
    v_lshlrev_b32 v229, 16, v215
    v_cvt_pk_bf16_f32 v236, v208, v209
    v_cvt_pk_bf16_f32 v237, v210, v211
    v_pk_mul_f32 v[226:227], v[224:225], s[44:45]
    v_pk_mul_f32 v[230:231], v[228:229], s[44:45]
    v_exp_f32 v226, v226
    v_exp_f32 v227, v227
    v_exp_f32 v230, v230
    v_exp_f32 v231, v231
    v_pk_add_f32 v[226:227], v[226:227], s[46:47]
    v_pk_add_f32 v[230:231], v[230:231], s[46:47]
    v_rcp_f32 v226, v226
    v_rcp_f32 v227, v227
    v_rcp_f32 v230, v230
    v_rcp_f32 v231, v231
    v_pk_mul_f32 v[224:225], v[224:225], v[226:227]
    v_pk_mul_f32 v[228:229], v[228:229], v[230:231]
    v_cvt_pk_bf16_f32 v226, 0, v224
    v_cvt_pk_bf16_f32 v227, 0, v225
    v_cvt_pk_bf16_f32 v230, 0, v228
    v_cvt_pk_bf16_f32 v231, 0, v229
    v_dot2_f32_bf16 v212, v226, v212, 0
    v_dot2_f32_bf16 v213, v227, v213, 0
    v_dot2_f32_bf16 v214, v230, v214, 0
    v_dot2_f32_bf16 v215, v231, v215, 0
    s_waitcnt lgkmcnt(0)
    v_lshlrev_b32 v224, 16, v216
    v_lshlrev_b32 v225, 16, v217
    v_lshlrev_b32 v228, 16, v218
    v_lshlrev_b32 v229, 16, v219
    v_cvt_pk_bf16_f32 v238, v212, v213
    v_cvt_pk_bf16_f32 v239, v214, v215
    buffer_store_dwordx4 v[236:239], v7, s[20:23], s41 offen offset:1024 sc1
    v_pk_mul_f32 v[226:227], v[224:225], s[44:45]
    v_pk_mul_f32 v[230:231], v[228:229], s[44:45]
    v_exp_f32 v226, v226
    v_exp_f32 v227, v227
    v_exp_f32 v230, v230
    v_exp_f32 v231, v231
    v_pk_add_f32 v[226:227], v[226:227], s[46:47]
    v_pk_add_f32 v[230:231], v[230:231], s[46:47]
    v_rcp_f32 v226, v226
    v_rcp_f32 v227, v227
    v_rcp_f32 v230, v230
    v_rcp_f32 v231, v231
    v_pk_mul_f32 v[224:225], v[224:225], v[226:227]
    v_pk_mul_f32 v[228:229], v[228:229], v[230:231]
    v_cvt_pk_bf16_f32 v226, 0, v224
    v_cvt_pk_bf16_f32 v227, 0, v225
    v_cvt_pk_bf16_f32 v230, 0, v228
    v_cvt_pk_bf16_f32 v231, 0, v229
    v_dot2_f32_bf16 v216, v226, v216, 0
    v_dot2_f32_bf16 v217, v227, v217, 0
    v_dot2_f32_bf16 v218, v230, v218, 0
    v_dot2_f32_bf16 v219, v231, v219, 0
    v_lshlrev_b32 v224, 16, v220
    v_lshlrev_b32 v225, 16, v221
    v_lshlrev_b32 v228, 16, v222
    v_lshlrev_b32 v229, 16, v223
    v_cvt_pk_bf16_f32 v232, v216, v217
    v_cvt_pk_bf16_f32 v233, v218, v219
    v_pk_mul_f32 v[226:227], v[224:225], s[44:45]
    v_pk_mul_f32 v[230:231], v[228:229], s[44:45]
    v_exp_f32 v226, v226
    v_exp_f32 v227, v227
    v_exp_f32 v230, v230
    v_exp_f32 v231, v231
    v_pk_add_f32 v[226:227], v[226:227], s[46:47]
    v_pk_add_f32 v[230:231], v[230:231], s[46:47]
    v_rcp_f32 v226, v226
    v_rcp_f32 v227, v227
    v_rcp_f32 v230, v230
    v_rcp_f32 v231, v231
    v_pk_mul_f32 v[224:225], v[224:225], v[226:227]
    v_pk_mul_f32 v[228:229], v[228:229], v[230:231]
    v_cvt_pk_bf16_f32 v226, 0, v224
    v_cvt_pk_bf16_f32 v227, 0, v225
    v_cvt_pk_bf16_f32 v230, 0, v228
    v_cvt_pk_bf16_f32 v231, 0, v229
    v_dot2_f32_bf16 v220, v226, v220, 0
    v_dot2_f32_bf16 v221, v227, v221, 0
    v_dot2_f32_bf16 v222, v230, v222, 0
    v_dot2_f32_bf16 v223, v231, v223, 0
    s_nop 0
    v_cvt_pk_bf16_f32 v234, v220, v221
    s_nop 0
    v_cvt_pk_bf16_f32 v235, v222, v223
    buffer_store_dwordx4 v[232:235], v7, s[20:23], s41 offen offset:2048 sc1
p4_kernel_end:
    s_endpgm
.globl p5_kernel
.p2align 8
.type p5_kernel,@function
p5_kernel:
    s_cmp_ge_u32 s2, 256
    s_cbranch_scc1 p5_kernel_end
    s_load_dwordx2 s[4:5], s[0:1], 56
    s_load_dwordx2 s[6:7], s[0:1], 72
    v_and_b32 v1, 63, v0
    v_lshrrev_b32 v2, 6, v0
    s_nop 0
    v_readfirstlane_b32 s3, v2
    s_and_b32 s8, s2, 3
    s_lshl_b32 s8, s8, 3
    s_lshr_b32 s9, s2, 3
    s_and_b32 s10, s9, 7
    s_add_u32 s8, s8, s10
    s_lshr_b32 s9, s9, 3
    s_bfe_u32 s10, s2, 0x10002
    s_lshl_b32 s10, s10, 2
    s_add_u32 s9, s9, s10
    v_lshlrev_b32 v5, 4, v1
    s_mul_i32 s30, s9, 48
    s_mul_i32 s31, s3, 12
    s_add_u32 s30, s30, s31
    s_mul_i32 s30, s30, 5120
    s_mul_i32 s32, s8, 192
    s_add_u32 s32, s32, s31
    s_lshl_b32 s32, s32, 10
    s_add_u32 s33, s32, 49152
    s_add_u32 s34, s32, 98304
    s_add_u32 s35, s32, 147456
    s_add_u32 s31, s30, 4096
    s_waitcnt lgkmcnt(0)
    s_add_u32 s12, s6, 0x1000000
    s_addc_u32 s13, s7, 0
    s_mov_b32 s14, 0x1e0000
    s_mov_b32 s15, 0x00020000
    s_add_u32 s16, s6, 0x1200000
    s_addc_u32 s17, s7, 0
    s_mov_b32 s18, 0x600000
    s_mov_b32 s19, 0x00020000
    buffer_load_dwordx4 v[128:131], v5, s[16:19], s32 offen
    buffer_load_dwordx4 v[8:11], v5, s[12:15], s30 offen offset:0
    buffer_load_dwordx4 v[132:135], v5, s[16:19], s33 offen
    buffer_load_dwordx4 v[12:15], v5, s[12:15], s30 offen offset:1024
    buffer_load_dwordx4 v[136:139], v5, s[16:19], s34 offen
    buffer_load_dwordx4 v[16:19], v5, s[12:15], s30 offen offset:2048
    buffer_load_dwordx4 v[140:143], v5, s[16:19], s35 offen
    buffer_load_dwordx4 v[20:23], v5, s[12:15], s30 offen offset:3072
    buffer_load_dwordx4 v[24:27], v5, s[12:15], s31 offen
    s_add_u32 s30, s30, 5120
    s_add_u32 s31, s31, 5120
    s_add_u32 s32, s32, 1024
    s_add_u32 s33, s33, 1024
    s_add_u32 s34, s34, 1024
    s_add_u32 s35, s35, 1024
    buffer_load_dwordx4 v[144:147], v5, s[16:19], s32 offen
    buffer_load_dwordx4 v[28:31], v5, s[12:15], s30 offen offset:0
    buffer_load_dwordx4 v[148:151], v5, s[16:19], s33 offen
    buffer_load_dwordx4 v[32:35], v5, s[12:15], s30 offen offset:1024
    buffer_load_dwordx4 v[152:155], v5, s[16:19], s34 offen
    buffer_load_dwordx4 v[36:39], v5, s[12:15], s30 offen offset:2048
    buffer_load_dwordx4 v[156:159], v5, s[16:19], s35 offen
    buffer_load_dwordx4 v[40:43], v5, s[12:15], s30 offen offset:3072
    buffer_load_dwordx4 v[44:47], v5, s[12:15], s31 offen
    s_add_u32 s30, s30, 5120
    s_add_u32 s31, s31, 5120
    s_add_u32 s32, s32, 1024
    s_add_u32 s33, s33, 1024
    s_add_u32 s34, s34, 1024
    s_add_u32 s35, s35, 1024
    buffer_load_dwordx4 v[160:163], v5, s[16:19], s32 offen
    buffer_load_dwordx4 v[48:51], v5, s[12:15], s30 offen offset:0
    buffer_load_dwordx4 v[164:167], v5, s[16:19], s33 offen
    buffer_load_dwordx4 v[52:55], v5, s[12:15], s30 offen offset:1024
    buffer_load_dwordx4 v[168:171], v5, s[16:19], s34 offen
    buffer_load_dwordx4 v[56:59], v5, s[12:15], s30 offen offset:2048
    buffer_load_dwordx4 v[172:175], v5, s[16:19], s35 offen
    buffer_load_dwordx4 v[60:63], v5, s[12:15], s30 offen offset:3072
    buffer_load_dwordx4 v[64:67], v5, s[12:15], s31 offen
    s_add_u32 s30, s30, 5120
    s_add_u32 s31, s31, 5120
    s_add_u32 s32, s32, 1024
    s_add_u32 s33, s33, 1024
    s_add_u32 s34, s34, 1024
    s_add_u32 s35, s35, 1024
    buffer_load_dwordx4 v[176:179], v5, s[16:19], s32 offen
    buffer_load_dwordx4 v[68:71], v5, s[12:15], s30 offen offset:0
    buffer_load_dwordx4 v[180:183], v5, s[16:19], s33 offen
    buffer_load_dwordx4 v[72:75], v5, s[12:15], s30 offen offset:1024
    buffer_load_dwordx4 v[184:187], v5, s[16:19], s34 offen
    buffer_load_dwordx4 v[76:79], v5, s[12:15], s30 offen offset:2048
    buffer_load_dwordx4 v[188:191], v5, s[16:19], s35 offen
    buffer_load_dwordx4 v[80:83], v5, s[12:15], s30 offen offset:3072
    buffer_load_dwordx4 v[84:87], v5, s[12:15], s31 offen
    s_add_u32 s30, s30, 5120
    s_add_u32 s31, s31, 5120
    s_add_u32 s32, s32, 1024
    s_add_u32 s33, s33, 1024
    s_add_u32 s34, s34, 1024
    s_add_u32 s35, s35, 1024
    buffer_load_dwordx4 v[192:195], v5, s[16:19], s32 offen
    buffer_load_dwordx4 v[88:91], v5, s[12:15], s30 offen offset:0
    buffer_load_dwordx4 v[196:199], v5, s[16:19], s33 offen
    buffer_load_dwordx4 v[92:95], v5, s[12:15], s30 offen offset:1024
    buffer_load_dwordx4 v[200:203], v5, s[16:19], s34 offen
    buffer_load_dwordx4 v[96:99], v5, s[12:15], s30 offen offset:2048
    buffer_load_dwordx4 v[204:207], v5, s[16:19], s35 offen
    buffer_load_dwordx4 v[100:103], v5, s[12:15], s30 offen offset:3072
    buffer_load_dwordx4 v[104:107], v5, s[12:15], s31 offen
    s_add_u32 s30, s30, 5120
    s_add_u32 s31, s31, 5120
    s_add_u32 s32, s32, 1024
    s_add_u32 s33, s33, 1024
    s_add_u32 s34, s34, 1024
    s_add_u32 s35, s35, 1024
    buffer_load_dwordx4 v[208:211], v5, s[16:19], s32 offen
    buffer_load_dwordx4 v[108:111], v5, s[12:15], s30 offen offset:0
    buffer_load_dwordx4 v[212:215], v5, s[16:19], s33 offen
    buffer_load_dwordx4 v[112:115], v5, s[12:15], s30 offen offset:1024
    buffer_load_dwordx4 v[216:219], v5, s[16:19], s34 offen
    buffer_load_dwordx4 v[116:119], v5, s[12:15], s30 offen offset:2048
    buffer_load_dwordx4 v[220:223], v5, s[16:19], s35 offen
    buffer_load_dwordx4 v[120:123], v5, s[12:15], s30 offen offset:3072
    buffer_load_dwordx4 v[124:127], v5, s[12:15], s31 offen
    s_add_u32 s30, s30, 5120
    s_add_u32 s31, s31, 5120
    s_add_u32 s32, s32, 1024
    s_add_u32 s33, s33, 1024
    s_add_u32 s34, s34, 1024
    s_add_u32 s35, s35, 1024
    s_lshl_b32 s36, s8, 6
    s_lshl_b32 s37, s3, 4
    s_add_u32 s36, s36, s37
    v_and_b32 v2, 15, v1
    v_add_u32 v2, s36, v2
    v_and_b32 v3, 7, v2
    v_lshrrev_b32 v2, 3, v2
    v_lshl_add_u32 v2, v3, 8, v2
    v_mul_u32_u24 v2, 1280, v2
    v_lshrrev_b32 v3, 4, v1
    v_mul_u32_u24 v3, 40, v3
    v_add_u32 v6, v2, v3
    s_mul_i32 s37, s9, 160
    s_add_u32 s20, s6, 0x600000
    s_addc_u32 s21, s7, 0
    s_mov_b32 s22, 0x280000
    s_mov_b32 s23, 0x00020000
    s_mov_b32 s24, s4
    s_mov_b32 s25, s5
    s_mov_b32 s26, 0x280000
    s_mov_b32 s27, 0x00020000
    s_waitcnt vmcnt(45)
    v_mfma_f32_16x16x32_bf16 a[0:3], v[8:11], v[128:131], 0
    v_mfma_f32_16x16x32_bf16 a[4:7], v[12:15], v[128:131], 0
    v_mfma_f32_16x16x32_bf16 a[8:11], v[16:19], v[128:131], 0
    v_mfma_f32_16x16x32_bf16 a[12:15], v[20:23], v[128:131], 0
    v_mfma_f32_16x16x32_bf16 a[16:19], v[24:27], v[128:131], 0
    v_mfma_f32_16x16x32_bf16 a[20:23], v[8:11], v[132:135], 0
    v_mfma_f32_16x16x32_bf16 a[24:27], v[12:15], v[132:135], 0
    v_mfma_f32_16x16x32_bf16 a[28:31], v[16:19], v[132:135], 0
    v_mfma_f32_16x16x32_bf16 a[32:35], v[20:23], v[132:135], 0
    v_mfma_f32_16x16x32_bf16 a[36:39], v[24:27], v[132:135], 0
    v_mfma_f32_16x16x32_bf16 a[40:43], v[8:11], v[136:139], 0
    v_mfma_f32_16x16x32_bf16 a[44:47], v[12:15], v[136:139], 0
    v_mfma_f32_16x16x32_bf16 a[48:51], v[16:19], v[136:139], 0
    v_mfma_f32_16x16x32_bf16 a[52:55], v[20:23], v[136:139], 0
    v_mfma_f32_16x16x32_bf16 a[56:59], v[24:27], v[136:139], 0
    v_mfma_f32_16x16x32_bf16 a[60:63], v[8:11], v[140:143], 0
    v_mfma_f32_16x16x32_bf16 a[64:67], v[12:15], v[140:143], 0
    v_mfma_f32_16x16x32_bf16 a[68:71], v[16:19], v[140:143], 0
    v_mfma_f32_16x16x32_bf16 a[72:75], v[20:23], v[140:143], 0
    v_mfma_f32_16x16x32_bf16 a[76:79], v[24:27], v[140:143], 0
    buffer_load_dwordx4 v[128:131], v5, s[16:19], s32 offen
    buffer_load_dwordx4 v[8:11], v5, s[12:15], s30 offen offset:0
    buffer_load_dwordx4 v[132:135], v5, s[16:19], s33 offen
    buffer_load_dwordx4 v[12:15], v5, s[12:15], s30 offen offset:1024
    buffer_load_dwordx4 v[136:139], v5, s[16:19], s34 offen
    buffer_load_dwordx4 v[16:19], v5, s[12:15], s30 offen offset:2048
    buffer_load_dwordx4 v[140:143], v5, s[16:19], s35 offen
    buffer_load_dwordx4 v[20:23], v5, s[12:15], s30 offen offset:3072
    buffer_load_dwordx4 v[24:27], v5, s[12:15], s31 offen
    s_add_u32 s30, s30, 5120
    s_add_u32 s31, s31, 5120
    s_add_u32 s32, s32, 1024
    s_add_u32 s33, s33, 1024
    s_add_u32 s34, s34, 1024
    s_add_u32 s35, s35, 1024
    s_waitcnt vmcnt(45)
    v_mfma_f32_16x16x32_bf16 a[0:3], v[28:31], v[144:147], a[0:3]
    v_mfma_f32_16x16x32_bf16 a[4:7], v[32:35], v[144:147], a[4:7]
    v_mfma_f32_16x16x32_bf16 a[8:11], v[36:39], v[144:147], a[8:11]
    v_mfma_f32_16x16x32_bf16 a[12:15], v[40:43], v[144:147], a[12:15]
    v_mfma_f32_16x16x32_bf16 a[16:19], v[44:47], v[144:147], a[16:19]
    v_mfma_f32_16x16x32_bf16 a[20:23], v[28:31], v[148:151], a[20:23]
    v_mfma_f32_16x16x32_bf16 a[24:27], v[32:35], v[148:151], a[24:27]
    v_mfma_f32_16x16x32_bf16 a[28:31], v[36:39], v[148:151], a[28:31]
    v_mfma_f32_16x16x32_bf16 a[32:35], v[40:43], v[148:151], a[32:35]
    v_mfma_f32_16x16x32_bf16 a[36:39], v[44:47], v[148:151], a[36:39]
    v_mfma_f32_16x16x32_bf16 a[40:43], v[28:31], v[152:155], a[40:43]
    v_mfma_f32_16x16x32_bf16 a[44:47], v[32:35], v[152:155], a[44:47]
    v_mfma_f32_16x16x32_bf16 a[48:51], v[36:39], v[152:155], a[48:51]
    v_mfma_f32_16x16x32_bf16 a[52:55], v[40:43], v[152:155], a[52:55]
    v_mfma_f32_16x16x32_bf16 a[56:59], v[44:47], v[152:155], a[56:59]
    v_mfma_f32_16x16x32_bf16 a[60:63], v[28:31], v[156:159], a[60:63]
    v_mfma_f32_16x16x32_bf16 a[64:67], v[32:35], v[156:159], a[64:67]
    v_mfma_f32_16x16x32_bf16 a[68:71], v[36:39], v[156:159], a[68:71]
    v_mfma_f32_16x16x32_bf16 a[72:75], v[40:43], v[156:159], a[72:75]
    v_mfma_f32_16x16x32_bf16 a[76:79], v[44:47], v[156:159], a[76:79]
    buffer_load_dwordx4 v[144:147], v5, s[16:19], s32 offen
    buffer_load_dwordx4 v[28:31], v5, s[12:15], s30 offen offset:0
    buffer_load_dwordx4 v[148:151], v5, s[16:19], s33 offen
    buffer_load_dwordx4 v[32:35], v5, s[12:15], s30 offen offset:1024
    buffer_load_dwordx4 v[152:155], v5, s[16:19], s34 offen
    buffer_load_dwordx4 v[36:39], v5, s[12:15], s30 offen offset:2048
    buffer_load_dwordx4 v[156:159], v5, s[16:19], s35 offen
    buffer_load_dwordx4 v[40:43], v5, s[12:15], s30 offen offset:3072
    buffer_load_dwordx4 v[44:47], v5, s[12:15], s31 offen
    s_add_u32 s30, s30, 5120
    s_add_u32 s31, s31, 5120
    s_add_u32 s32, s32, 1024
    s_add_u32 s33, s33, 1024
    s_add_u32 s34, s34, 1024
    s_add_u32 s35, s35, 1024
    s_waitcnt vmcnt(45)
    v_mfma_f32_16x16x32_bf16 a[0:3], v[48:51], v[160:163], a[0:3]
    v_mfma_f32_16x16x32_bf16 a[4:7], v[52:55], v[160:163], a[4:7]
    v_mfma_f32_16x16x32_bf16 a[8:11], v[56:59], v[160:163], a[8:11]
    v_mfma_f32_16x16x32_bf16 a[12:15], v[60:63], v[160:163], a[12:15]
    v_mfma_f32_16x16x32_bf16 a[16:19], v[64:67], v[160:163], a[16:19]
    v_mfma_f32_16x16x32_bf16 a[20:23], v[48:51], v[164:167], a[20:23]
    v_mfma_f32_16x16x32_bf16 a[24:27], v[52:55], v[164:167], a[24:27]
    v_mfma_f32_16x16x32_bf16 a[28:31], v[56:59], v[164:167], a[28:31]
    v_mfma_f32_16x16x32_bf16 a[32:35], v[60:63], v[164:167], a[32:35]
    v_mfma_f32_16x16x32_bf16 a[36:39], v[64:67], v[164:167], a[36:39]
    v_mfma_f32_16x16x32_bf16 a[40:43], v[48:51], v[168:171], a[40:43]
    v_mfma_f32_16x16x32_bf16 a[44:47], v[52:55], v[168:171], a[44:47]
    v_mfma_f32_16x16x32_bf16 a[48:51], v[56:59], v[168:171], a[48:51]
    v_mfma_f32_16x16x32_bf16 a[52:55], v[60:63], v[168:171], a[52:55]
    v_mfma_f32_16x16x32_bf16 a[56:59], v[64:67], v[168:171], a[56:59]
    v_mfma_f32_16x16x32_bf16 a[60:63], v[48:51], v[172:175], a[60:63]
    v_mfma_f32_16x16x32_bf16 a[64:67], v[52:55], v[172:175], a[64:67]
    v_mfma_f32_16x16x32_bf16 a[68:71], v[56:59], v[172:175], a[68:71]
    v_mfma_f32_16x16x32_bf16 a[72:75], v[60:63], v[172:175], a[72:75]
    v_mfma_f32_16x16x32_bf16 a[76:79], v[64:67], v[172:175], a[76:79]
    buffer_load_dwordx4 v[160:163], v5, s[16:19], s32 offen
    buffer_load_dwordx4 v[48:51], v5, s[12:15], s30 offen offset:0
    buffer_load_dwordx4 v[164:167], v5, s[16:19], s33 offen
    buffer_load_dwordx4 v[52:55], v5, s[12:15], s30 offen offset:1024
    buffer_load_dwordx4 v[168:171], v5, s[16:19], s34 offen
    buffer_load_dwordx4 v[56:59], v5, s[12:15], s30 offen offset:2048
    buffer_load_dwordx4 v[172:175], v5, s[16:19], s35 offen
    buffer_load_dwordx4 v[60:63], v5, s[12:15], s30 offen offset:3072
    buffer_load_dwordx4 v[64:67], v5, s[12:15], s31 offen
    s_add_u32 s30, s30, 5120
    s_add_u32 s31, s31, 5120
    s_add_u32 s32, s32, 1024
    s_add_u32 s33, s33, 1024
    s_add_u32 s34, s34, 1024
    s_add_u32 s35, s35, 1024
    s_waitcnt vmcnt(45)
    v_mfma_f32_16x16x32_bf16 a[0:3], v[68:71], v[176:179], a[0:3]
    v_mfma_f32_16x16x32_bf16 a[4:7], v[72:75], v[176:179], a[4:7]
    v_mfma_f32_16x16x32_bf16 a[8:11], v[76:79], v[176:179], a[8:11]
    v_mfma_f32_16x16x32_bf16 a[12:15], v[80:83], v[176:179], a[12:15]
    v_mfma_f32_16x16x32_bf16 a[16:19], v[84:87], v[176:179], a[16:19]
    v_mfma_f32_16x16x32_bf16 a[20:23], v[68:71], v[180:183], a[20:23]
    v_mfma_f32_16x16x32_bf16 a[24:27], v[72:75], v[180:183], a[24:27]
    v_mfma_f32_16x16x32_bf16 a[28:31], v[76:79], v[180:183], a[28:31]
    v_mfma_f32_16x16x32_bf16 a[32:35], v[80:83], v[180:183], a[32:35]
    v_mfma_f32_16x16x32_bf16 a[36:39], v[84:87], v[180:183], a[36:39]
    v_mfma_f32_16x16x32_bf16 a[40:43], v[68:71], v[184:187], a[40:43]
    v_mfma_f32_16x16x32_bf16 a[44:47], v[72:75], v[184:187], a[44:47]
    v_mfma_f32_16x16x32_bf16 a[48:51], v[76:79], v[184:187], a[48:51]
    v_mfma_f32_16x16x32_bf16 a[52:55], v[80:83], v[184:187], a[52:55]
    v_mfma_f32_16x16x32_bf16 a[56:59], v[84:87], v[184:187], a[56:59]
    v_mfma_f32_16x16x32_bf16 a[60:63], v[68:71], v[188:191], a[60:63]
    v_mfma_f32_16x16x32_bf16 a[64:67], v[72:75], v[188:191], a[64:67]
    v_mfma_f32_16x16x32_bf16 a[68:71], v[76:79], v[188:191], a[68:71]
    v_mfma_f32_16x16x32_bf16 a[72:75], v[80:83], v[188:191], a[72:75]
    v_mfma_f32_16x16x32_bf16 a[76:79], v[84:87], v[188:191], a[76:79]
    buffer_load_dwordx4 v[176:179], v5, s[16:19], s32 offen
    buffer_load_dwordx4 v[68:71], v5, s[12:15], s30 offen offset:0
    buffer_load_dwordx4 v[180:183], v5, s[16:19], s33 offen
    buffer_load_dwordx4 v[72:75], v5, s[12:15], s30 offen offset:1024
    buffer_load_dwordx4 v[184:187], v5, s[16:19], s34 offen
    buffer_load_dwordx4 v[76:79], v5, s[12:15], s30 offen offset:2048
    buffer_load_dwordx4 v[188:191], v5, s[16:19], s35 offen
    buffer_load_dwordx4 v[80:83], v5, s[12:15], s30 offen offset:3072
    buffer_load_dwordx4 v[84:87], v5, s[12:15], s31 offen
    s_add_u32 s30, s30, 5120
    s_add_u32 s31, s31, 5120
    s_add_u32 s32, s32, 1024
    s_add_u32 s33, s33, 1024
    s_add_u32 s34, s34, 1024
    s_add_u32 s35, s35, 1024
    s_waitcnt vmcnt(45)
    v_mfma_f32_16x16x32_bf16 a[0:3], v[88:91], v[192:195], a[0:3]
    v_mfma_f32_16x16x32_bf16 a[4:7], v[92:95], v[192:195], a[4:7]
    v_mfma_f32_16x16x32_bf16 a[8:11], v[96:99], v[192:195], a[8:11]
    v_mfma_f32_16x16x32_bf16 a[12:15], v[100:103], v[192:195], a[12:15]
    v_mfma_f32_16x16x32_bf16 a[16:19], v[104:107], v[192:195], a[16:19]
    v_mfma_f32_16x16x32_bf16 a[20:23], v[88:91], v[196:199], a[20:23]
    v_mfma_f32_16x16x32_bf16 a[24:27], v[92:95], v[196:199], a[24:27]
    v_mfma_f32_16x16x32_bf16 a[28:31], v[96:99], v[196:199], a[28:31]
    v_mfma_f32_16x16x32_bf16 a[32:35], v[100:103], v[196:199], a[32:35]
    v_mfma_f32_16x16x32_bf16 a[36:39], v[104:107], v[196:199], a[36:39]
    v_mfma_f32_16x16x32_bf16 a[40:43], v[88:91], v[200:203], a[40:43]
    v_mfma_f32_16x16x32_bf16 a[44:47], v[92:95], v[200:203], a[44:47]
    v_mfma_f32_16x16x32_bf16 a[48:51], v[96:99], v[200:203], a[48:51]
    v_mfma_f32_16x16x32_bf16 a[52:55], v[100:103], v[200:203], a[52:55]
    v_mfma_f32_16x16x32_bf16 a[56:59], v[104:107], v[200:203], a[56:59]
    v_mfma_f32_16x16x32_bf16 a[60:63], v[88:91], v[204:207], a[60:63]
    v_mfma_f32_16x16x32_bf16 a[64:67], v[92:95], v[204:207], a[64:67]
    v_mfma_f32_16x16x32_bf16 a[68:71], v[96:99], v[204:207], a[68:71]
    v_mfma_f32_16x16x32_bf16 a[72:75], v[100:103], v[204:207], a[72:75]
    v_mfma_f32_16x16x32_bf16 a[76:79], v[104:107], v[204:207], a[76:79]
    buffer_load_dwordx4 v[192:195], v5, s[16:19], s32 offen
    buffer_load_dwordx4 v[88:91], v5, s[12:15], s30 offen offset:0
    buffer_load_dwordx4 v[196:199], v5, s[16:19], s33 offen
    buffer_load_dwordx4 v[92:95], v5, s[12:15], s30 offen offset:1024
    buffer_load_dwordx4 v[200:203], v5, s[16:19], s34 offen
    buffer_load_dwordx4 v[96:99], v5, s[12:15], s30 offen offset:2048
    buffer_load_dwordx4 v[204:207], v5, s[16:19], s35 offen
    buffer_load_dwordx4 v[100:103], v5, s[12:15], s30 offen offset:3072
    buffer_load_dwordx4 v[104:107], v5, s[12:15], s31 offen
    s_add_u32 s30, s30, 5120
    s_add_u32 s31, s31, 5120
    s_add_u32 s32, s32, 1024
    s_add_u32 s33, s33, 1024
    s_add_u32 s34, s34, 1024
    s_add_u32 s35, s35, 1024
    s_waitcnt vmcnt(45)
    v_mfma_f32_16x16x32_bf16 a[0:3], v[108:111], v[208:211], a[0:3]
    v_mfma_f32_16x16x32_bf16 a[4:7], v[112:115], v[208:211], a[4:7]
    v_mfma_f32_16x16x32_bf16 a[8:11], v[116:119], v[208:211], a[8:11]
    v_mfma_f32_16x16x32_bf16 a[12:15], v[120:123], v[208:211], a[12:15]
    v_mfma_f32_16x16x32_bf16 a[16:19], v[124:127], v[208:211], a[16:19]
    v_mfma_f32_16x16x32_bf16 a[20:23], v[108:111], v[212:215], a[20:23]
    v_mfma_f32_16x16x32_bf16 a[24:27], v[112:115], v[212:215], a[24:27]
    v_mfma_f32_16x16x32_bf16 a[28:31], v[116:119], v[212:215], a[28:31]
    v_mfma_f32_16x16x32_bf16 a[32:35], v[120:123], v[212:215], a[32:35]
    v_mfma_f32_16x16x32_bf16 a[36:39], v[124:127], v[212:215], a[36:39]
    v_mfma_f32_16x16x32_bf16 a[40:43], v[108:111], v[216:219], a[40:43]
    v_mfma_f32_16x16x32_bf16 a[44:47], v[112:115], v[216:219], a[44:47]
    v_mfma_f32_16x16x32_bf16 a[48:51], v[116:119], v[216:219], a[48:51]
    v_mfma_f32_16x16x32_bf16 a[52:55], v[120:123], v[216:219], a[52:55]
    v_mfma_f32_16x16x32_bf16 a[56:59], v[124:127], v[216:219], a[56:59]
    v_mfma_f32_16x16x32_bf16 a[60:63], v[108:111], v[220:223], a[60:63]
    v_mfma_f32_16x16x32_bf16 a[64:67], v[112:115], v[220:223], a[64:67]
    v_mfma_f32_16x16x32_bf16 a[68:71], v[116:119], v[220:223], a[68:71]
    v_mfma_f32_16x16x32_bf16 a[72:75], v[120:123], v[220:223], a[72:75]
    v_mfma_f32_16x16x32_bf16 a[76:79], v[124:127], v[220:223], a[76:79]
    buffer_load_dwordx4 v[208:211], v5, s[16:19], s32 offen
    buffer_load_dwordx4 v[108:111], v5, s[12:15], s30 offen offset:0
    buffer_load_dwordx4 v[212:215], v5, s[16:19], s33 offen
    buffer_load_dwordx4 v[112:115], v5, s[12:15], s30 offen offset:1024
    buffer_load_dwordx4 v[216:219], v5, s[16:19], s34 offen
    buffer_load_dwordx4 v[116:119], v5, s[12:15], s30 offen offset:2048
    buffer_load_dwordx4 v[220:223], v5, s[16:19], s35 offen
    buffer_load_dwordx4 v[120:123], v5, s[12:15], s30 offen offset:3072
    buffer_load_dwordx4 v[124:127], v5, s[12:15], s31 offen
    s_waitcnt vmcnt(45)
    v_mfma_f32_16x16x32_bf16 a[0:3], v[8:11], v[128:131], a[0:3]
    v_mfma_f32_16x16x32_bf16 a[4:7], v[12:15], v[128:131], a[4:7]
    v_mfma_f32_16x16x32_bf16 a[8:11], v[16:19], v[128:131], a[8:11]
    v_mfma_f32_16x16x32_bf16 a[12:15], v[20:23], v[128:131], a[12:15]
    v_mfma_f32_16x16x32_bf16 a[16:19], v[24:27], v[128:131], a[16:19]
    v_mfma_f32_16x16x32_bf16 a[20:23], v[8:11], v[132:135], a[20:23]
    v_mfma_f32_16x16x32_bf16 a[24:27], v[12:15], v[132:135], a[24:27]
    v_mfma_f32_16x16x32_bf16 a[28:31], v[16:19], v[132:135], a[28:31]
    v_mfma_f32_16x16x32_bf16 a[32:35], v[20:23], v[132:135], a[32:35]
    v_mfma_f32_16x16x32_bf16 a[36:39], v[24:27], v[132:135], a[36:39]
    v_mfma_f32_16x16x32_bf16 a[40:43], v[8:11], v[136:139], a[40:43]
    v_mfma_f32_16x16x32_bf16 a[44:47], v[12:15], v[136:139], a[44:47]
    v_mfma_f32_16x16x32_bf16 a[48:51], v[16:19], v[136:139], a[48:51]
    v_mfma_f32_16x16x32_bf16 a[52:55], v[20:23], v[136:139], a[52:55]
    v_mfma_f32_16x16x32_bf16 a[56:59], v[24:27], v[136:139], a[56:59]
    v_mfma_f32_16x16x32_bf16 a[60:63], v[8:11], v[140:143], a[60:63]
    v_mfma_f32_16x16x32_bf16 a[64:67], v[12:15], v[140:143], a[64:67]
    v_mfma_f32_16x16x32_bf16 a[68:71], v[16:19], v[140:143], a[68:71]
    v_mfma_f32_16x16x32_bf16 a[72:75], v[20:23], v[140:143], a[72:75]
    v_mfma_f32_16x16x32_bf16 a[76:79], v[24:27], v[140:143], a[76:79]
    buffer_load_dwordx4 v[224:227], v6, s[20:23], s37 offen
    buffer_load_dwordx4 v[228:231], v6, s[20:23], s37 offen offset:16
    buffer_load_dwordx2 v[232:233], v6, s[20:23], s37 offen offset:32
    s_waitcnt vmcnt(39)
    v_mfma_f32_16x16x32_bf16 a[0:3], v[28:31], v[144:147], a[0:3]
    v_mfma_f32_16x16x32_bf16 a[4:7], v[32:35], v[144:147], a[4:7]
    v_mfma_f32_16x16x32_bf16 a[8:11], v[36:39], v[144:147], a[8:11]
    v_mfma_f32_16x16x32_bf16 a[12:15], v[40:43], v[144:147], a[12:15]
    v_mfma_f32_16x16x32_bf16 a[16:19], v[44:47], v[144:147], a[16:19]
    v_mfma_f32_16x16x32_bf16 a[20:23], v[28:31], v[148:151], a[20:23]
    v_mfma_f32_16x16x32_bf16 a[24:27], v[32:35], v[148:151], a[24:27]
    v_mfma_f32_16x16x32_bf16 a[28:31], v[36:39], v[148:151], a[28:31]
    v_mfma_f32_16x16x32_bf16 a[32:35], v[40:43], v[148:151], a[32:35]
    v_mfma_f32_16x16x32_bf16 a[36:39], v[44:47], v[148:151], a[36:39]
    v_mfma_f32_16x16x32_bf16 a[40:43], v[28:31], v[152:155], a[40:43]
    v_mfma_f32_16x16x32_bf16 a[44:47], v[32:35], v[152:155], a[44:47]
    v_mfma_f32_16x16x32_bf16 a[48:51], v[36:39], v[152:155], a[48:51]
    v_mfma_f32_16x16x32_bf16 a[52:55], v[40:43], v[152:155], a[52:55]
    v_mfma_f32_16x16x32_bf16 a[56:59], v[44:47], v[152:155], a[56:59]
    v_mfma_f32_16x16x32_bf16 a[60:63], v[28:31], v[156:159], a[60:63]
    v_mfma_f32_16x16x32_bf16 a[64:67], v[32:35], v[156:159], a[64:67]
    v_mfma_f32_16x16x32_bf16 a[68:71], v[36:39], v[156:159], a[68:71]
    v_mfma_f32_16x16x32_bf16 a[72:75], v[40:43], v[156:159], a[72:75]
    v_mfma_f32_16x16x32_bf16 a[76:79], v[44:47], v[156:159], a[76:79]
    s_waitcnt vmcnt(30)
    v_mfma_f32_16x16x32_bf16 a[0:3], v[48:51], v[160:163], a[0:3]
    v_mfma_f32_16x16x32_bf16 a[4:7], v[52:55], v[160:163], a[4:7]
    v_mfma_f32_16x16x32_bf16 a[8:11], v[56:59], v[160:163], a[8:11]
    v_mfma_f32_16x16x32_bf16 a[12:15], v[60:63], v[160:163], a[12:15]
    v_mfma_f32_16x16x32_bf16 a[16:19], v[64:67], v[160:163], a[16:19]
    v_mfma_f32_16x16x32_bf16 a[20:23], v[48:51], v[164:167], a[20:23]
    v_mfma_f32_16x16x32_bf16 a[24:27], v[52:55], v[164:167], a[24:27]
    v_mfma_f32_16x16x32_bf16 a[28:31], v[56:59], v[164:167], a[28:31]
    v_mfma_f32_16x16x32_bf16 a[32:35], v[60:63], v[164:167], a[32:35]
    v_mfma_f32_16x16x32_bf16 a[36:39], v[64:67], v[164:167], a[36:39]
    v_mfma_f32_16x16x32_bf16 a[40:43], v[48:51], v[168:171], a[40:43]
    v_mfma_f32_16x16x32_bf16 a[44:47], v[52:55], v[168:171], a[44:47]
    v_mfma_f32_16x16x32_bf16 a[48:51], v[56:59], v[168:171], a[48:51]
    v_mfma_f32_16x16x32_bf16 a[52:55], v[60:63], v[168:171], a[52:55]
    v_mfma_f32_16x16x32_bf16 a[56:59], v[64:67], v[168:171], a[56:59]
    v_mfma_f32_16x16x32_bf16 a[60:63], v[48:51], v[172:175], a[60:63]
    v_mfma_f32_16x16x32_bf16 a[64:67], v[52:55], v[172:175], a[64:67]
    v_mfma_f32_16x16x32_bf16 a[68:71], v[56:59], v[172:175], a[68:71]
    v_mfma_f32_16x16x32_bf16 a[72:75], v[60:63], v[172:175], a[72:75]
    v_mfma_f32_16x16x32_bf16 a[76:79], v[64:67], v[172:175], a[76:79]
    s_waitcnt vmcnt(21)
    v_mfma_f32_16x16x32_bf16 a[0:3], v[68:71], v[176:179], a[0:3]
    v_mfma_f32_16x16x32_bf16 a[4:7], v[72:75], v[176:179], a[4:7]
    v_mfma_f32_16x16x32_bf16 a[8:11], v[76:79], v[176:179], a[8:11]
    v_mfma_f32_16x16x32_bf16 a[12:15], v[80:83], v[176:179], a[12:15]
    v_mfma_f32_16x16x32_bf16 a[16:19], v[84:87], v[176:179], a[16:19]
    v_mfma_f32_16x16x32_bf16 a[20:23], v[68:71], v[180:183], a[20:23]
    v_mfma_f32_16x16x32_bf16 a[24:27], v[72:75], v[180:183], a[24:27]
    v_mfma_f32_16x16x32_bf16 a[28:31], v[76:79], v[180:183], a[28:31]
    v_mfma_f32_16x16x32_bf16 a[32:35], v[80:83], v[180:183], a[32:35]
    v_mfma_f32_16x16x32_bf16 a[36:39], v[84:87], v[180:183], a[36:39]
    v_mfma_f32_16x16x32_bf16 a[40:43], v[68:71], v[184:187], a[40:43]
    v_mfma_f32_16x16x32_bf16 a[44:47], v[72:75], v[184:187], a[44:47]
    v_mfma_f32_16x16x32_bf16 a[48:51], v[76:79], v[184:187], a[48:51]
    v_mfma_f32_16x16x32_bf16 a[52:55], v[80:83], v[184:187], a[52:55]
    v_mfma_f32_16x16x32_bf16 a[56:59], v[84:87], v[184:187], a[56:59]
    v_mfma_f32_16x16x32_bf16 a[60:63], v[68:71], v[188:191], a[60:63]
    v_mfma_f32_16x16x32_bf16 a[64:67], v[72:75], v[188:191], a[64:67]
    v_mfma_f32_16x16x32_bf16 a[68:71], v[76:79], v[188:191], a[68:71]
    v_mfma_f32_16x16x32_bf16 a[72:75], v[80:83], v[188:191], a[72:75]
    v_mfma_f32_16x16x32_bf16 a[76:79], v[84:87], v[188:191], a[76:79]
    s_waitcnt vmcnt(12)
    v_mfma_f32_16x16x32_bf16 a[0:3], v[88:91], v[192:195], a[0:3]
    v_mfma_f32_16x16x32_bf16 a[4:7], v[92:95], v[192:195], a[4:7]
    v_mfma_f32_16x16x32_bf16 a[8:11], v[96:99], v[192:195], a[8:11]
    v_mfma_f32_16x16x32_bf16 a[12:15], v[100:103], v[192:195], a[12:15]
    v_mfma_f32_16x16x32_bf16 a[16:19], v[104:107], v[192:195], a[16:19]
    v_mfma_f32_16x16x32_bf16 a[20:23], v[88:91], v[196:199], a[20:23]
    v_mfma_f32_16x16x32_bf16 a[24:27], v[92:95], v[196:199], a[24:27]
    v_mfma_f32_16x16x32_bf16 a[28:31], v[96:99], v[196:199], a[28:31]
    v_mfma_f32_16x16x32_bf16 a[32:35], v[100:103], v[196:199], a[32:35]
    v_mfma_f32_16x16x32_bf16 a[36:39], v[104:107], v[196:199], a[36:39]
    v_mfma_f32_16x16x32_bf16 a[40:43], v[88:91], v[200:203], a[40:43]
    v_mfma_f32_16x16x32_bf16 a[44:47], v[92:95], v[200:203], a[44:47]
    v_mfma_f32_16x16x32_bf16 a[48:51], v[96:99], v[200:203], a[48:51]
    v_mfma_f32_16x16x32_bf16 a[52:55], v[100:103], v[200:203], a[52:55]
    v_mfma_f32_16x16x32_bf16 a[56:59], v[104:107], v[200:203], a[56:59]
    v_mfma_f32_16x16x32_bf16 a[60:63], v[88:91], v[204:207], a[60:63]
    v_mfma_f32_16x16x32_bf16 a[64:67], v[92:95], v[204:207], a[64:67]
    v_mfma_f32_16x16x32_bf16 a[68:71], v[96:99], v[204:207], a[68:71]
    v_mfma_f32_16x16x32_bf16 a[72:75], v[100:103], v[204:207], a[72:75]
    v_mfma_f32_16x16x32_bf16 a[76:79], v[104:107], v[204:207], a[76:79]
    s_waitcnt vmcnt(3)
    v_mfma_f32_16x16x32_bf16 a[0:3], v[108:111], v[208:211], a[0:3]
    v_mfma_f32_16x16x32_bf16 a[4:7], v[112:115], v[208:211], a[4:7]
    v_mfma_f32_16x16x32_bf16 a[8:11], v[116:119], v[208:211], a[8:11]
    v_mfma_f32_16x16x32_bf16 a[12:15], v[120:123], v[208:211], a[12:15]
    v_mfma_f32_16x16x32_bf16 a[16:19], v[124:127], v[208:211], a[16:19]
    v_mfma_f32_16x16x32_bf16 a[20:23], v[108:111], v[212:215], a[20:23]
    v_mfma_f32_16x16x32_bf16 a[24:27], v[112:115], v[212:215], a[24:27]
    v_mfma_f32_16x16x32_bf16 a[28:31], v[116:119], v[212:215], a[28:31]
    v_mfma_f32_16x16x32_bf16 a[32:35], v[120:123], v[212:215], a[32:35]
    v_mfma_f32_16x16x32_bf16 a[36:39], v[124:127], v[212:215], a[36:39]
    v_mfma_f32_16x16x32_bf16 a[40:43], v[108:111], v[216:219], a[40:43]
    v_mfma_f32_16x16x32_bf16 a[44:47], v[112:115], v[216:219], a[44:47]
    v_mfma_f32_16x16x32_bf16 a[48:51], v[116:119], v[216:219], a[48:51]
    v_mfma_f32_16x16x32_bf16 a[52:55], v[120:123], v[216:219], a[52:55]
    v_mfma_f32_16x16x32_bf16 a[56:59], v[124:127], v[216:219], a[56:59]
    v_mfma_f32_16x16x32_bf16 a[60:63], v[108:111], v[220:223], a[60:63]
    v_mfma_f32_16x16x32_bf16 a[64:67], v[112:115], v[220:223], a[64:67]
    v_mfma_f32_16x16x32_bf16 a[68:71], v[116:119], v[220:223], a[68:71]
    v_mfma_f32_16x16x32_bf16 a[72:75], v[120:123], v[220:223], a[72:75]
    v_mfma_f32_16x16x32_bf16 a[76:79], v[124:127], v[220:223], a[76:79]
    s_cmp_eq_u32 s3, 0
    s_cbranch_scc1 p5_own0
    s_sub_u32 s38, s3, 1
    s_and_b32 s38, s38, 3
    s_add_u32 s38, s38, 0
    s_mul_i32 s38, s38, 5120
    v_add_u32 v7, s38, v5
    ds_write_b128 v7, a[0:3] offset:0
    ds_write_b128 v7, a[4:7] offset:1024
    ds_write_b128 v7, a[8:11] offset:2048
    ds_write_b128 v7, a[12:15] offset:3072
    ds_write_b128 v7, a[16:19] offset:4096
    s_branch p5_next0
p5_own0:
    v_accvgpr_read_b32 v28, a0
    v_accvgpr_read_b32 v29, a1
    v_accvgpr_read_b32 v30, a2
    v_accvgpr_read_b32 v31, a3
    v_accvgpr_read_b32 v32, a4
    v_accvgpr_read_b32 v33, a5
    v_accvgpr_read_b32 v34, a6
    v_accvgpr_read_b32 v35, a7
    v_accvgpr_read_b32 v36, a8
    v_accvgpr_read_b32 v37, a9
    v_accvgpr_read_b32 v38, a10
    v_accvgpr_read_b32 v39, a11
    v_accvgpr_read_b32 v40, a12
    v_accvgpr_read_b32 v41, a13
    v_accvgpr_read_b32 v42, a14
    v_accvgpr_read_b32 v43, a15
    v_accvgpr_read_b32 v44, a16
    v_accvgpr_read_b32 v45, a17
    v_accvgpr_read_b32 v46, a18
    v_accvgpr_read_b32 v47, a19
p5_next0:
    s_cmp_eq_u32 s3, 1
    s_cbranch_scc1 p5_own1
    s_sub_u32 s38, s3, 2
    s_and_b32 s38, s38, 3
    s_add_u32 s38, s38, 3
    s_mul_i32 s38, s38, 5120
    v_add_u32 v7, s38, v5
    ds_write_b128 v7, a[20:23] offset:0
    ds_write_b128 v7, a[24:27] offset:1024
    ds_write_b128 v7, a[28:31] offset:2048
    ds_write_b128 v7, a[32:35] offset:3072
    ds_write_b128 v7, a[36:39] offset:4096
    s_branch p5_next1
p5_own1:
    v_accvgpr_read_b32 v28, a20
    v_accvgpr_read_b32 v29, a21
    v_accvgpr_read_b32 v30, a22
    v_accvgpr_read_b32 v31, a23
    v_accvgpr_read_b32 v32, a24
    v_accvgpr_read_b32 v33, a25
    v_accvgpr_read_b32 v34, a26
    v_accvgpr_read_b32 v35, a27
    v_accvgpr_read_b32 v36, a28
    v_accvgpr_read_b32 v37, a29
    v_accvgpr_read_b32 v38, a30
    v_accvgpr_read_b32 v39, a31
    v_accvgpr_read_b32 v40, a32
    v_accvgpr_read_b32 v41, a33
    v_accvgpr_read_b32 v42, a34
    v_accvgpr_read_b32 v43, a35
    v_accvgpr_read_b32 v44, a36
    v_accvgpr_read_b32 v45, a37
    v_accvgpr_read_b32 v46, a38
    v_accvgpr_read_b32 v47, a39
p5_next1:
    s_cmp_eq_u32 s3, 2
    s_cbranch_scc1 p5_own2
    s_sub_u32 s38, s3, 3
    s_and_b32 s38, s38, 3
    s_add_u32 s38, s38, 6
    s_mul_i32 s38, s38, 5120
    v_add_u32 v7, s38, v5
    ds_write_b128 v7, a[40:43] offset:0
    ds_write_b128 v7, a[44:47] offset:1024
    ds_write_b128 v7, a[48:51] offset:2048
    ds_write_b128 v7, a[52:55] offset:3072
    ds_write_b128 v7, a[56:59] offset:4096
    s_branch p5_next2
p5_own2:
    v_accvgpr_read_b32 v28, a40
    v_accvgpr_read_b32 v29, a41
    v_accvgpr_read_b32 v30, a42
    v_accvgpr_read_b32 v31, a43
    v_accvgpr_read_b32 v32, a44
    v_accvgpr_read_b32 v33, a45
    v_accvgpr_read_b32 v34, a46
    v_accvgpr_read_b32 v35, a47
    v_accvgpr_read_b32 v36, a48
    v_accvgpr_read_b32 v37, a49
    v_accvgpr_read_b32 v38, a50
    v_accvgpr_read_b32 v39, a51
    v_accvgpr_read_b32 v40, a52
    v_accvgpr_read_b32 v41, a53
    v_accvgpr_read_b32 v42, a54
    v_accvgpr_read_b32 v43, a55
    v_accvgpr_read_b32 v44, a56
    v_accvgpr_read_b32 v45, a57
    v_accvgpr_read_b32 v46, a58
    v_accvgpr_read_b32 v47, a59
p5_next2:
    s_cmp_eq_u32 s3, 3
    s_cbranch_scc1 p5_own3
    s_sub_u32 s38, s3, 4
    s_and_b32 s38, s38, 3
    s_add_u32 s38, s38, 9
    s_mul_i32 s38, s38, 5120
    v_add_u32 v7, s38, v5
    ds_write_b128 v7, a[60:63] offset:0
    ds_write_b128 v7, a[64:67] offset:1024
    ds_write_b128 v7, a[68:71] offset:2048
    ds_write_b128 v7, a[72:75] offset:3072
    ds_write_b128 v7, a[76:79] offset:4096
    s_branch p5_next3
p5_own3:
    v_accvgpr_read_b32 v28, a60
    v_accvgpr_read_b32 v29, a61
    v_accvgpr_read_b32 v30, a62
    v_accvgpr_read_b32 v31, a63
    v_accvgpr_read_b32 v32, a64
    v_accvgpr_read_b32 v33, a65
    v_accvgpr_read_b32 v34, a66
    v_accvgpr_read_b32 v35, a67
    v_accvgpr_read_b32 v36, a68
    v_accvgpr_read_b32 v37, a69
    v_accvgpr_read_b32 v38, a70
    v_accvgpr_read_b32 v39, a71
    v_accvgpr_read_b32 v40, a72
    v_accvgpr_read_b32 v41, a73
    v_accvgpr_read_b32 v42, a74
    v_accvgpr_read_b32 v43, a75
    v_accvgpr_read_b32 v44, a76
    v_accvgpr_read_b32 v45, a77
    v_accvgpr_read_b32 v46, a78
    v_accvgpr_read_b32 v47, a79
p5_next3:
    s_mul_i32 s38, s3, 15360
    v_add_u32 v236, s38, v5
    s_waitcnt vmcnt(0)
    v_lshlrev_b32 v8, 16, v224
    v_and_b32 v9, 0xffff0000, v224
    v_lshlrev_b32 v10, 16, v225
    v_and_b32 v11, 0xffff0000, v225
    v_lshlrev_b32 v12, 16, v226
    v_and_b32 v13, 0xffff0000, v226
    v_lshlrev_b32 v14, 16, v227
    v_and_b32 v15, 0xffff0000, v227
    v_lshlrev_b32 v16, 16, v228
    v_and_b32 v17, 0xffff0000, v228
    v_lshlrev_b32 v18, 16, v229
    v_and_b32 v19, 0xffff0000, v229
    v_lshlrev_b32 v20, 16, v230
    v_and_b32 v21, 0xffff0000, v230
    v_lshlrev_b32 v22, 16, v231
    v_and_b32 v23, 0xffff0000, v231
    v_lshlrev_b32 v24, 16, v232
    v_and_b32 v25, 0xffff0000, v232
    v_lshlrev_b32 v26, 16, v233
    v_and_b32 v27, 0xffff0000, v233
    s_waitcnt lgkmcnt(0)
    s_barrier
    ds_read_b128 v[48:51], v236 offset:0
    ds_read_b128 v[52:55], v236 offset:1024
    ds_read_b128 v[56:59], v236 offset:2048
    ds_read_b128 v[60:63], v236 offset:3072
    ds_read_b128 v[64:67], v236 offset:4096
    ds_read_b128 v[68:71], v236 offset:5120
    ds_read_b128 v[72:75], v236 offset:6144
    ds_read_b128 v[76:79], v236 offset:7168
    ds_read_b128 v[80:83], v236 offset:8192
    ds_read_b128 v[84:87], v236 offset:9216
    ds_read_b128 v[88:91], v236 offset:10240
    ds_read_b128 v[92:95], v236 offset:11264
    ds_read_b128 v[96:99], v236 offset:12288
    ds_read_b128 v[100:103], v236 offset:13312
    ds_read_b128 v[104:107], v236 offset:14336
    s_waitcnt lgkmcnt(10)
    v_pk_add_f32 v[28:29], v[28:29], v[48:49]
    v_pk_add_f32 v[30:31], v[30:31], v[50:51]
    v_pk_add_f32 v[32:33], v[32:33], v[52:53]
    v_pk_add_f32 v[34:35], v[34:35], v[54:55]
    v_pk_add_f32 v[36:37], v[36:37], v[56:57]
    v_pk_add_f32 v[38:39], v[38:39], v[58:59]
    v_pk_add_f32 v[40:41], v[40:41], v[60:61]
    v_pk_add_f32 v[42:43], v[42:43], v[62:63]
    v_pk_add_f32 v[44:45], v[44:45], v[64:65]
    v_pk_add_f32 v[46:47], v[46:47], v[66:67]
    s_waitcnt lgkmcnt(5)
    v_pk_add_f32 v[28:29], v[28:29], v[68:69]
    v_pk_add_f32 v[30:31], v[30:31], v[70:71]
    v_pk_add_f32 v[32:33], v[32:33], v[72:73]
    v_pk_add_f32 v[34:35], v[34:35], v[74:75]
    v_pk_add_f32 v[36:37], v[36:37], v[76:77]
    v_pk_add_f32 v[38:39], v[38:39], v[78:79]
    v_pk_add_f32 v[40:41], v[40:41], v[80:81]
    v_pk_add_f32 v[42:43], v[42:43], v[82:83]
    v_pk_add_f32 v[44:45], v[44:45], v[84:85]
    v_pk_add_f32 v[46:47], v[46:47], v[86:87]
    s_waitcnt lgkmcnt(0)
    v_pk_add_f32 v[28:29], v[28:29], v[88:89]
    v_pk_add_f32 v[30:31], v[30:31], v[90:91]
    v_pk_add_f32 v[32:33], v[32:33], v[92:93]
    v_pk_add_f32 v[34:35], v[34:35], v[94:95]
    v_pk_add_f32 v[36:37], v[36:37], v[96:97]
    v_pk_add_f32 v[38:39], v[38:39], v[98:99]
    v_pk_add_f32 v[40:41], v[40:41], v[100:101]
    v_pk_add_f32 v[42:43], v[42:43], v[102:103]
    v_pk_add_f32 v[44:45], v[44:45], v[104:105]
    v_pk_add_f32 v[46:47], v[46:47], v[106:107]
    v_cvt_pk_bf16_f32 v2, v28, v29
    v_lshlrev_b32 v238, 16, v2
    v_and_b32 v239, 0xffff0000, v2
    v_pk_add_f32 v[238:239], v[8:9], v[238:239]
    v_cvt_pk_bf16_f32 v128, v238, v239
    v_cvt_pk_bf16_f32 v3, v30, v31
    v_lshlrev_b32 v240, 16, v3
    v_and_b32 v241, 0xffff0000, v3
    v_pk_add_f32 v[240:241], v[10:11], v[240:241]
    v_cvt_pk_bf16_f32 v129, v240, v241
    v_cvt_pk_bf16_f32 v2, v32, v33
    v_lshlrev_b32 v238, 16, v2
    v_and_b32 v239, 0xffff0000, v2
    v_pk_add_f32 v[238:239], v[12:13], v[238:239]
    v_cvt_pk_bf16_f32 v130, v238, v239
    v_cvt_pk_bf16_f32 v3, v34, v35
    v_lshlrev_b32 v240, 16, v3
    v_and_b32 v241, 0xffff0000, v3
    v_pk_add_f32 v[240:241], v[14:15], v[240:241]
    v_cvt_pk_bf16_f32 v131, v240, v241
    v_cvt_pk_bf16_f32 v2, v36, v37
    v_lshlrev_b32 v238, 16, v2
    v_and_b32 v239, 0xffff0000, v2
    v_pk_add_f32 v[238:239], v[16:17], v[238:239]
    v_cvt_pk_bf16_f32 v132, v238, v239
    v_cvt_pk_bf16_f32 v3, v38, v39
    v_lshlrev_b32 v240, 16, v3
    v_and_b32 v241, 0xffff0000, v3
    v_pk_add_f32 v[240:241], v[18:19], v[240:241]
    v_cvt_pk_bf16_f32 v133, v240, v241
    v_cvt_pk_bf16_f32 v2, v40, v41
    v_lshlrev_b32 v238, 16, v2
    v_and_b32 v239, 0xffff0000, v2
    v_pk_add_f32 v[238:239], v[20:21], v[238:239]
    v_cvt_pk_bf16_f32 v134, v238, v239
    v_cvt_pk_bf16_f32 v3, v42, v43
    v_lshlrev_b32 v240, 16, v3
    v_and_b32 v241, 0xffff0000, v3
    v_pk_add_f32 v[240:241], v[22:23], v[240:241]
    v_cvt_pk_bf16_f32 v135, v240, v241
    v_cvt_pk_bf16_f32 v2, v44, v45
    v_lshlrev_b32 v238, 16, v2
    v_and_b32 v239, 0xffff0000, v2
    v_pk_add_f32 v[238:239], v[24:25], v[238:239]
    v_cvt_pk_bf16_f32 v136, v238, v239
    v_cvt_pk_bf16_f32 v3, v46, v47
    v_lshlrev_b32 v240, 16, v3
    v_and_b32 v241, 0xffff0000, v3
    v_pk_add_f32 v[240:241], v[26:27], v[240:241]
    v_cvt_pk_bf16_f32 v137, v240, v241
    buffer_store_dwordx4 v[128:131], v6, s[24:27], s37 offen
    buffer_store_dwordx4 v[132:135], v6, s[24:27], s37 offen offset:16
    buffer_store_dwordx2 v[136:137], v6, s[24:27], s37 offen offset:32
p5_kernel_end:
    s_endpgm
.section .rodata,"a"
.p2align 7
ro_first:
.p2align 6
.amdhsa_kernel p1_kernel
  .amdhsa_next_free_vgpr 128
  .amdhsa_next_free_sgpr 100
  .amdhsa_accum_offset 128
  .amdhsa_group_segment_fixed_size 0
  .amdhsa_kernarg_size 80
  .amdhsa_user_sgpr_count 2
  .amdhsa_user_sgpr_kernarg_segment_ptr 1
  .amdhsa_system_sgpr_workgroup_id_x 1
.end_amdhsa_kernel
.p2align 6
.amdhsa_kernel p2_kernel
  .amdhsa_next_free_vgpr 100
  .amdhsa_next_free_sgpr 62
  .amdhsa_accum_offset 100
  .amdhsa_group_segment_fixed_size 0
  .amdhsa_kernarg_size 80
  .amdhsa_user_sgpr_count 2
  .amdhsa_user_sgpr_kernarg_segment_ptr 1
  .amdhsa_system_sgpr_workgroup_id_x 1
.end_amdhsa_kernel
.p2align 6
.amdhsa_kernel p3_kernel
  .amdhsa_next_free_vgpr 124
  .amdhsa_next_free_sgpr 62
  .amdhsa_accum_offset 124
  .amdhsa_group_segment_fixed_size 0
  .amdhsa_kernarg_size 80
  .amdhsa_user_sgpr_count 2
  .amdhsa_user_sgpr_kernarg_segment_ptr 1
  .amdhsa_system_sgpr_workgroup_id_x 1
.end_amdhsa_kernel
.p2align 6
.amdhsa_kernel p4_kernel
  .amdhsa_next_free_vgpr 240
  .amdhsa_next_free_sgpr 62
  .amdhsa_accum_offset 240
  .amdhsa_group_segment_fixed_size 0
  .amdhsa_kernarg_size 80
  .amdhsa_user_sgpr_count 2
  .amdhsa_user_sgpr_kernarg_segment_ptr 1
  .amdhsa_system_sgpr_workgroup_id_x 1
.end_amdhsa_kernel
.p2align 6
.amdhsa_kernel p5_kernel
  .amdhsa_next_free_vgpr 324
  .amdhsa_next_free_sgpr 39
  .amdhsa_accum_offset 244
  .amdhsa_group_segment_fixed_size 0
  .amdhsa_kernarg_size 80
  .amdhsa_user_sgpr_count 2
  .amdhsa_user_sgpr_kernarg_segment_ptr 1
  .amdhsa_system_sgpr_workgroup_id_x 1
.end_amdhsa_kernel
.p2align 7
p3_tab:
.long 0x100000,0x300020,0xc0,0x0,0x500040,0x700060,0xc0,0x0
.long 0x900080,0x79c00a0,0x600007ac,0x0,0x77c078c,0x75c076c,0xc00000c0,0x0
.long 0x73c074c,0x71c072c,0xc00000c0,0x0,0x140004,0x340024,0x70c,0x0
.long 0x540044,0x740064,0xc0,0x0,0x940084,0x79800a4,0x600007a8,0x0
.long 0x7780788,0x7580768,0xc00000c0,0x0,0x7380748,0x7180728,0xc00000c0,0x0
.long 0x180008,0x380028,0x708,0x0,0x580048,0x780068,0xc0,0x0
.long 0x980088,0x79400a8,0x600007a4,0x0,0x7740784,0x7540764,0xc00000c0,0x0
.long 0x7340744,0x7140724,0xc00000c0,0x0,0x1c000c,0x3c002c,0x704,0x0
.long 0x5c004c,0x7c006c,0xc0,0x0,0x9c008c,0x79000ac,0x600007a0,0x0
.long 0x7700780,0x7500760,0xc00000c0,0x0,0x7300740,0x7100720,0xc00000c0,0x0
.long 0x1100100,0x1300120,0x700,0x0,0x1500140,0x1700160,0xc0,0x0
.long 0x1900180,0x69c01a0,0x600006ac,0x0,0x67c068c,0x65c066c,0xc00000c0,0x0
.long 0x63c064c,0x61c062c,0xc00000c0,0x0,0x1140104,0x1340124,0x60c,0x0
.long 0x1540144,0x1740164,0xc0,0x0,0x1940184,0x69801a4,0x600006a8,0x0
.long 0x6780688,0x6580668,0xc00000c0,0x0,0x6380648,0x6180628,0xc00000c0,0x0
.long 0x1180108,0x1380128,0x608,0x0,0x1580148,0x1780168,0xc0,0x0
.long 0x1980188,0x69401a8,0x600006a4,0x0,0x6740684,0x6540664,0xc00000c0,0x0
.long 0x6340644,0x6140624,0xc00000c0,0x0,0x11c010c,0x13c012c,0x604,0x0
.long 0x15c014c,0x17c016c,0xc0,0x0,0x19c018c,0x69001ac,0x600006a0,0x0
.long 0x6700680,0x6500660,0xc00000c0,0x0,0x6300640,0x6100620,0xc00000c0,0x0
.long 0x2100200,0x2300220,0x600,0x0,0x2500240,0x2700260,0xc0,0x0
.long 0x2900280,0x59c02a0,0x600005ac,0x0,0x57c058c,0x55c056c,0xc00000c0,0x0
.long 0x53c054c,0x51c052c,0xc00000c0,0x0,0x2140204,0x2340224,0x50c,0x0
.long 0x2540244,0x2740264,0xc0,0x0,0x2940284,0x59802a4,0x600005a8,0x0
.long 0x5780588,0x5580568,0xc00000c0,0x0,0x5380548,0x5180528,0xc00000c0,0x0
.long 0x2180208,0x2380228,0x508,0x0,0x2580248,0x2780268,0xc0,0x0
.long 0x2980288,0x59402a8,0x600005a4,0x0,0x5740584,0x5540564,0xc00000c0,0x0
.long 0x5340544,0x5140524,0xc00000c0,0x0,0x21c020c,0x23c022c,0x504,0x0
.long 0x25c024c,0x27c026c,0xc0,0x0,0x29c028c,0x59002ac,0x600005a0,0x0
.long 0x5700580,0x5500560,0xc00000c0,0x0,0x5300540,0x5100520,0xc00000c0,0x0
.long 0x3100300,0x3300320,0x500,0x0,0x3500340,0x3700360,0xc0,0x0
.long 0x3900380,0x49c03a0,0x600004ac,0x0,0x47c048c,0x45c046c,0xc00000c0,0x0
.long 0x43c044c,0x41c042c,0xc00000c0,0x0,0x3140304,0x3340324,0x40c,0x0
.long 0x3540344,0x3740364,0xc0,0x0,0x3940384,0x49803a4,0x600004a8,0x0
.long 0x4780488,0x4580468,0xc00000c0,0x0,0x4380448,0x4180428,0xc00000c0,0x0
.long 0x3180308,0x3380328,0x408,0x0,0x3580348,0x3780368,0xc0,0x0
.long 0x3980388,0x49403a8,0x600004a4,0x0,0x4740484,0x4540464,0xc00000c0,0x0
.long 0x4340444,0x4140424,0xc00000c0,0x0,0x31c030c,0x33c032c,0x404,0x0
.long 0x35c034c,0x37c036c,0xc0,0x0,0x39c038c,0x49003ac,0x600004a0,0x0
.long 0x4700480,0x4500460,0xc00000c0,0x0,0x4300440,0x4100420,0xc00000c0,0x0
.long 0xc00400,0xc000c0,0xc0,0x0,0xc000c0,0xc000c0,0xc0,0x0
.long 0xc000c0,0xc000c0,0x600000c0,0x0,0xc000c0,0xc000c0,0xc00000c0,0x0
.long 0xc000c0,0xc000c0,0xc00000c0,0x0,0xc000c0,0xc000c0,0xc0,0x0
.long 0xc000c0,0xc000c0,0xc0,0x0,0xc000c0,0xc000c0,0x600000c0,0x0
.long 0xc000c0,0xc000c0,0xc00000c0,0x0,0xc000c0,0xc000c0,0xc00000c0,0x0
.long 0xc000c0,0xc000c0,0xc0,0x0,0xc000c0,0xc000c0,0xc0,0x0
.long 0xc000c0,0xc000c0,0x600000c0,0x0,0xc000c0,0xc000c0,0xc00000c0,0x0
.long 0xc000c0,0xc000c0,0xc00000c0,0x0,0xc000c0,0xc000c0,0xc0,0x0
.long 0xc000c0,0xc000c0,0xc0,0x0,0xc000c0,0xc000c0,0x600000c0,0x0
.long 0xc000c0,0xc000c0,0xc00000c0,0x0,0xc000c0,0xc000c0,0xc00000c0,0x0
.long 0xc000c0,0xc000c0,0xc0,0x0,0xc000c0,0xc000c0,0xc0,0x0
.long 0xc000c0,0xc000c0,0x600000c0,0x0,0xc000c0,0xc000c0,0xc00000c0,0x0
.long 0xc000c0,0xc000c0,0xc00000c0,0x0,0xc000c0,0xc000c0,0xc0,0x0
.long 0xc000c0,0xc000c0,0xc0,0x0,0xc000c0,0xc000c0,0x600000c0,0x0
.long 0xc000c0,0xc000c0,0xc00000c0,0x0,0xc000c0,0xc000c0,0xc00000c0,0x0
.long 0xc000c0,0xc000c0,0xc0,0x0,0xc000c0,0xc000c0,0xc0,0x0
.long 0xc000c0,0xc000c0,0x600000c0,0x0,0xc000c0,0xc000c0,0xc00000c0,0x0
.long 0xc000c0,0xc000c0,0xc00000c0,0x0,0xc000c0,0xc000c0,0xc0,0x0
.long 0xc000c0,0xc000c0,0xc0,0x0,0xc000c0,0xc000c0,0x600000c0,0x0
.long 0xc000c0,0xc000c0,0xc00000c0,0x0,0xc000c0,0xc000c0,0xc00000c0,0x0
.long 0xc000c0,0xc000c0,0xc0,0x0,0xc000c0,0xc000c0,0xc0,0x0
.long 0xc000c0,0xc000c0,0x600000c0,0x0,0xc000c0,0xc000c0,0xc00000c0,0x0
.long 0xc000c0,0xc000c0,0xc00000c0,0x0,0xc000c0,0xc000c0,0xc0,0x0
.long 0xc000c0,0xc000c0,0xc0,0x0,0xc000c0,0xc000c0,0x600000c0,0x0
.long 0x80003f80,0x80003f80,0x80003f80,0x80003f80,0x80003f80,0xbe483f7b,0xbec43f6d,0xbf0e3f55
.long 0x80003f80,0xbec43f6d,0xbf353f35,0xbf6d3ec4,0x80003f80,0xbf0e3f55,0xbf6d3ec4,0xbf7bbe48
.long 0x80003f80,0xbf80248d,0xa50dbf80,0x3f80a554,0x80003f80,0xbf7bbe48,0x3ec4bf6d,0x3f553f0e
.long 0x80003f80,0xbf6dbec4,0x3f35bf35,0x3ec43f6d,0x80003f80,0xbf55bf0e,0x3f6dbec4,0xbe483f7b
.long 0x80003f80,0xa50dbf80,0x80003f80,0xa50dbf80,0x80003f80,0x3e48bf7b,0xbec43f6d,0x3f0ebf55
.long 0x80003f80,0x3ec4bf6d,0xbf353f35,0x3f6dbec4,0x80003f80,0x3f0ebf55,0xbf6d3ec4,0x3f7b3e48
.long 0x80003f80,0x3f80a554,0xa50dbf80,0xbf80248d,0x80003f80,0x3f7b3e48,0x3ec4bf6d,0xbf55bf0e
.long 0x80003f80,0x3f6d3ec4,0x3f35bf35,0xbec4bf6d,0x80003f80,0x3f553f0e,0x3f6dbec4,0x3e48bf7b
.long 0x80003f80,0x80003f80,0x80003f80,0x80003f80,0xbf353f35,0xbf553f0e,0xbf6d3ec4,0xbf7b3e48
.long 0xbf80248d,0xbf6dbec4,0xbf35bf35,0xbec4bf6d,0xbf35bf35,0xbe48bf7b,0x3ec4bf6d,0x3f55bf0e
.long 0x80003f80,0xbf80248d,0xa50dbf80,0x3f80a554,0xbf353f35,0xbf0ebf55,0x3f6dbec4,0x3e483f7b
.long 0xbf80248d,0x3ec4bf6d,0x3f353f35,0xbf6d3ec4,0xbf35bf35,0x3f7bbe48,0xbec43f6d,0xbf0ebf55
.long 0x80003f80,0xa50dbf80,0x80003f80,0xa50dbf80,0xbf353f35,0x3f55bf0e,0xbf6d3ec4,0x3f7bbe48
.long 0xbf80248d,0x3f6d3ec4,0xbf35bf35,0x3ec43f6d,0xbf35bf35,0x3e483f7b,0x3ec4bf6d,0xbf553f0e
.long 0x80003f80,0x3f80a554,0xa50dbf80,0xbf80248d,0xbf353f35,0x3f0e3f55,0x3f6dbec4,0xbe48bf7b
.long 0xbf80248d,0xbec43f6d,0x3f353f35,0x3f6dbec4,0xbf35bf35,0xbf7b3e48,0xbec43f6d,0x3f0e3f55
.long 0x80003f80,0x80003f80,0x80003f80,0x80003f80,0xbf80248d,0xbf7bbe48,0xbf6dbec4,0xbf55bf0e
.long 0xa50dbf80,0x3ec4bf6d,0x3f35bf35,0x3f6dbec4,0x3f80a554,0x3f553f0e,0x3ec43f6d,0xbe483f7b
.long 0x80003f80,0xbf80248d,0xa50dbf80,0x3f80a554,0xbf80248d,0x3e48bf7b,0x3f6d3ec4,0xbf0e3f55
.long 0xa50dbf80,0x3f6d3ec4,0xbf353f35,0xbec4bf6d,0x3f80a554,0xbf0e3f55,0xbec4bf6d,0x3f7b3e48
.long 0x80003f80,0xa50dbf80,0x80003f80,0xa50dbf80,0xbf80248d,0x3f7b3e48,0xbf6dbec4,0x3f553f0e
.long 0xa50dbf80,0xbec43f6d,0x3f35bf35,0xbf6d3ec4,0x3f80a554,0xbf55bf0e,0x3ec43f6d,0x3e48bf7b
.long 0x80003f80,0x3f80a554,0xa50dbf80,0xbf80248d,0xbf80248d,0xbe483f7b,0x3f6d3ec4,0x3f0ebf55
.long 0xa50dbf80,0xbf6dbec4,0xbf353f35,0x3ec43f6d,0x3f80a554,0x3f0ebf55,0xbec4bf6d,0xbf7bbe48
.long 0x80003f80,0x80003f80,0x80003f80,0x80003f80,0xbf35bf35,0xbf0ebf55,0xbec4bf6d,0xbe48bf7b
.long 0x3f80a554,0x3f6d3ec4,0x3f353f35,0x3ec43f6d,0xbf353f35,0xbf7b3e48,0xbf6dbec4,0xbf0ebf55
.long 0x80003f80,0xbf80248d,0xa50dbf80,0x3f80a554,0xbf35bf35,0x3f55bf0e,0x3ec43f6d,0xbf7b3e48
.long 0x3f80a554,0xbec43f6d,0xbf35bf35,0x3f6dbec4,0xbf353f35,0xbe48bf7b,0x3f6d3ec4,0xbf553f0e
.long 0x80003f80,0xa50dbf80,0x80003f80,0xa50dbf80,0xbf35bf35,0x3f0e3f55,0xbec4bf6d,0x3e483f7b
.long 0x3f80a554,0xbf6dbec4,0x3f353f35,0xbec4bf6d,0xbf353f35,0x3f7bbe48,0xbf6dbec4,0x3f0e3f55
.long 0x80003f80,0x3f80a554,0xa50dbf80,0xbf80248d,0xbf35bf35,0xbf553f0e,0x3ec43f6d,0x3f7bbe48
.long 0x3f80a554,0x3ec4bf6d,0xbf35bf35,0xbf6d3ec4,0xbf353f35,0x3e483f7b,0x3f6d3ec4,0x3f55bf0e
.long 0x3f800000,0x3f800000,0x3f800000,0x3f800000,0x3f800000,0x3f7b3e48,0x3f6d3ec4,0x3f553f0e
.long 0x3f800000,0x3f6d3ec4,0x3f353f35,0x3ec43f6d,0x3f800000,0x3f553f0e,0x3ec43f6d,0xbe483f7b
.long 0x3f800000,0x248d3f80,0xbf80250d,0xa554bf80,0x3f800000,0xbe483f7b,0xbf6dbec4,0x3f0ebf55
.long 0x3f800000,0xbec43f6d,0xbf35bf35,0x3f6dbec4,0x3f800000,0xbf0e3f55,0xbec4bf6d,0x3f7b3e48
.long 0x3f800000,0xbf80250d,0x3f800000,0xbf80250d,0x3f800000,0xbf7bbe48,0x3f6d3ec4,0xbf55bf0e
.long 0x3f800000,0xbf6dbec4,0x3f353f35,0xbec4bf6d,0x3f800000,0xbf55bf0e,0x3ec43f6d,0x3e48bf7b
.long 0x3f800000,0xa554bf80,0xbf80250d,0x248d3f80,0x3f800000,0x3e48bf7b,0xbf6dbec4,0xbf0e3f55
.long 0x3f800000,0x3ec4bf6d,0xbf35bf35,0xbf6d3ec4,0x3f800000,0x3f0ebf55,0xbec4bf6d,0xbf7bbe48
.long 0x3f800000,0x3f800000,0x3f800000,0x3f800000,0x3f353f35,0x3f0e3f55,0x3ec43f6d,0x3e483f7b
.long 0x248d3f80,0xbec43f6d,0xbf353f35,0xbf6d3ec4,0xbf353f35,0xbf7b3e48,0xbf6dbec4,0xbf0ebf55
.long 0x3f800000,0x248d3f80,0xbf80250d,0xa554bf80,0x3f353f35,0xbf553f0e,0xbec4bf6d,0x3f7bbe48
.long 0x248d3f80,0xbf6dbec4,0x3f35bf35,0x3ec43f6d,0xbf353f35,0xbe48bf7b,0x3f6d3ec4,0xbf553f0e
.long 0x3f800000,0xbf80250d,0x3f800000,0xbf80250d,0x3f353f35,0xbf0ebf55,0x3ec43f6d,0xbe48bf7b
.long 0x248d3f80,0x3ec4bf6d,0xbf353f35,0x3f6dbec4,0xbf353f35,0x3f7bbe48,0xbf6dbec4,0x3f0e3f55
.long 0x3f800000,0xa554bf80,0xbf80250d,0x248d3f80,0x3f353f35,0x3f55bf0e,0xbec4bf6d,0xbf7b3e48
.long 0x248d3f80,0x3f6d3ec4,0x3f35bf35,0xbec4bf6d,0xbf353f35,0x3e483f7b,0x3f6d3ec4,0x3f55bf0e
.long 0x3f800000,0x3f800000,0x3f800000,0x3f800000,0x248d3f80,0xbe483f7b,0xbec43f6d,0xbf0e3f55
.long 0xbf80250d,0xbf6dbec4,0xbf35bf35,0xbec4bf6d,0xa554bf80,0x3f0ebf55,0x3f6dbec4,0x3f7b3e48
.long 0x3f800000,0x248d3f80,0xbf80250d,0xa554bf80,0x248d3f80,0xbf7bbe48,0x3ec4bf6d,0x3f553f0e
.long 0xbf80250d,0x3ec4bf6d,0x3f353f35,0xbf6d3ec4,0xa554bf80,0x3f553f0e,0xbf6d3ec4,0x3e48bf7b
.long 0x3f800000,0xbf80250d,0x3f800000,0xbf80250d,0x248d3f80,0x3e48bf7b,0xbec43f6d,0x3f0ebf55
.long 0xbf80250d,0x3f6d3ec4,0xbf35bf35,0x3ec43f6d,0xa554bf80,0xbf0e3f55,0x3f6dbec4,0xbf7bbe48
.long 0x3f800000,0xa554bf80,0xbf80250d,0x248d3f80,0x248d3f80,0x3f7b3e48,0x3ec4bf6d,0xbf55bf0e
.long 0xbf80250d,0xbec43f6d,0x3f353f35,0x3f6dbec4,0xa554bf80,0xbf55bf0e,0xbf6d3ec4,0xbe483f7b
.long 0x3f800000,0x3f800000,0x3f800000,0x3f800000,0xbf353f35,0xbf553f0e,0xbf6d3ec4,0xbf7b3e48
.long 0xa554bf80,0x3ec4bf6d,0x3f35bf35,0x3f6dbec4,0x3f353f35,0x3e483f7b,0xbec43f6d,0xbf553f0e
.long 0x3f800000,0x248d3f80,0xbf80250d,0xa554bf80,0xbf353f35,0xbf0ebf55,0x3f6dbec4,0x3e483f7b
.long 0xa554bf80,0x3f6d3ec4,0xbf353f35,0xbec4bf6d,0x3f353f35,0xbf7b3e48,0x3ec4bf6d,0x3f0e3f55
.long 0x3f800000,0xbf80250d,0x3f800000,0xbf80250d,0xbf353f35,0x3f55bf0e,0xbf6d3ec4,0x3f7bbe48
.long 0xa554bf80,0xbec43f6d,0x3f35bf35,0xbf6d3ec4,0x3f353f35,0xbe48bf7b,0xbec43f6d,0x3f55bf0e
.long 0x3f800000,0xa554bf80,0xbf80250d,0x248d3f80,0xbf353f35,0x3f0e3f55,0x3f6dbec4,0xbe48bf7b
.long 0xa554bf80,0xbf6dbec4,0xbf353f35,0x3ec43f6d,0x3f353f35,0x3f7bbe48,0x3ec4bf6d,0xbf0ebf55
.long 0x80003f80,0x80003f80,0x80003f80,0x80003f80,0xa50dbf80,0x3e48bf7b,0x3ec4bf6d,0x3f0ebf55
.long 0x80003f80,0xbec43f6d,0xbf353f35,0xbf6d3ec4,0xa50dbf80,0x3f0ebf55,0x3f6dbec4,0x3f7b3e48
.long 0x80003f80,0xbf80248d,0xa50dbf80,0x3f80a554,0xa50dbf80,0x3f7b3e48,0xbec43f6d,0xbf55bf0e
.long 0x80003f80,0xbf6dbec4,0x3f35bf35,0x3ec43f6d,0xa50dbf80,0x3f553f0e,0xbf6d3ec4,0x3e48bf7b
.long 0x80003f80,0xa50dbf80,0x80003f80,0xa50dbf80,0xa50dbf80,0xbe483f7b,0x3ec4bf6d,0xbf0e3f55
.long 0x80003f80,0x3ec4bf6d,0xbf353f35,0x3f6dbec4,0xa50dbf80,0xbf0e3f55,0x3f6dbec4,0xbf7bbe48
.long 0x80003f80,0x3f80a554,0xa50dbf80,0xbf80248d,0xa50dbf80,0xbf7bbe48,0xbec43f6d,0x3f553f0e
.long 0x80003f80,0x3f6d3ec4,0x3f35bf35,0xbec4bf6d,0xa50dbf80,0xbf55bf0e,0xbf6d3ec4,0xbe483f7b
.long 0x80003f80,0x80003f80,0x80003f80,0x80003f80,0x3f35bf35,0x3f55bf0e,0x3f6dbec4,0x3f7bbe48
.long 0xbf80248d,0xbf6dbec4,0xbf35bf35,0xbec4bf6d,0x3f353f35,0x3e483f7b,0xbec43f6d,0xbf553f0e
.long 0x80003f80,0xbf80248d,0xa50dbf80,0x3f80a554,0x3f35bf35,0x3f0e3f55,0xbf6d3ec4,0xbe48bf7b
.long 0xbf80248d,0x3ec4bf6d,0x3f353f35,0xbf6d3ec4,0x3f353f35,0xbf7b3e48,0x3ec4bf6d,0x3f0e3f55
.long 0x80003f80,0xa50dbf80,0x80003f80,0xa50dbf80,0x3f35bf35,0xbf553f0e,0x3f6dbec4,0xbf7b3e48
.long 0xbf80248d,0x3f6d3ec4,0xbf35bf35,0x3ec43f6d,0x3f353f35,0xbe48bf7b,0xbec43f6d,0x3f55bf0e
.long 0x80003f80,0x3f80a554,0xa50dbf80,0xbf80248d,0x3f35bf35,0xbf0ebf55,0xbf6d3ec4,0x3e483f7b
.long 0xbf80248d,0xbec43f6d,0x3f353f35,0x3f6dbec4,0x3f353f35,0x3f7bbe48,0x3ec4bf6d,0xbf0ebf55
.long 0x80003f80,0x80003f80,0x80003f80,0x80003f80,0x3f80a554,0x3f7b3e48,0x3f6d3ec4,0x3f553f0e
.long 0xa50dbf80,0x3ec4bf6d,0x3f35bf35,0x3f6dbec4,0xbf80248d,0xbf55bf0e,0xbec4bf6d,0x3e48bf7b
.long 0x80003f80,0xbf80248d,0xa50dbf80,0x3f80a554,0x3f80a554,0xbe483f7b,0xbf6dbec4,0x3f0ebf55
.long 0xa50dbf80,0x3f6d3ec4,0xbf353f35,0xbec4bf6d,0xbf80248d,0x3f0ebf55,0x3ec43f6d,0xbf7bbe48
.long 0x80003f80,0xa50dbf80,0x80003f80,0xa50dbf80,0x3f80a554,0xbf7bbe48,0x3f6d3ec4,0xbf55bf0e
.long 0xa50dbf80,0xbec43f6d,0x3f35bf35,0xbf6d3ec4,0xbf80248d,0x3f553f0e,0xbec4bf6d,0xbe483f7b
.long 0x80003f80,0x3f80a554,0xa50dbf80,0xbf80248d,0x3f80a554,0x3e48bf7b,0xbf6dbec4,0xbf0e3f55
.long 0xa50dbf80,0xbf6dbec4,0xbf353f35,0x3ec43f6d,0xbf80248d,0xbf0e3f55,0x3ec43f6d,0x3f7b3e48
.long 0x80003f80,0x80003f80,0x80003f80,0x80003f80,0x3f353f35,0x3f0e3f55,0x3ec43f6d,0x3e483f7b
.long 0x3f80a554,0x3f6d3ec4,0x3f353f35,0x3ec43f6d,0x3f35bf35,0x3f7bbe48,0x3f6d3ec4,0x3f0e3f55
.long 0x80003f80,0xbf80248d,0xa50dbf80,0x3f80a554,0x3f353f35,0xbf553f0e,0xbec4bf6d,0x3f7bbe48
.long 0x3f80a554,0xbec43f6d,0xbf35bf35,0x3f6dbec4,0x3f35bf35,0x3e483f7b,0xbf6dbec4,0x3f55bf0e
.long 0x80003f80,0xa50dbf80,0x80003f80,0xa50dbf80,0x3f353f35,0xbf0ebf55,0x3ec43f6d,0xbe48bf7b
.long 0x3f80a554,0xbf6dbec4,0x3f353f35,0xbec4bf6d,0x3f35bf35,0xbf7b3e48,0x3f6d3ec4,0xbf0ebf55
.long 0x80003f80,0x3f80a554,0xa50dbf80,0xbf80248d,0x3f353f35,0x3f55bf0e,0xbec4bf6d,0xbf7b3e48
.long 0x3f80a554,0x3ec4bf6d,0xbf35bf35,0xbf6d3ec4,0x3f35bf35,0xbe48bf7b,0xbf6dbec4,0xbf553f0e
.long 0x3f800000,0x3f800000,0x3f800000,0x3f800000,0xbf80250d,0xbf7bbe48,0xbf6dbec4,0xbf55bf0e
.long 0x3f800000,0x3f6d3ec4,0x3f353f35,0x3ec43f6d,0xbf80250d,0xbf55bf0e,0xbec4bf6d,0x3e48bf7b
.long 0x3f800000,0x248d3f80,0xbf80250d,0xa554bf80,0xbf80250d,0x3e48bf7b,0x3f6d3ec4,0xbf0e3f55
.long 0x3f800000,0xbec43f6d,0xbf35bf35,0x3f6dbec4,0xbf80250d,0x3f0ebf55,0x3ec43f6d,0xbf7bbe48
.long 0x3f800000,0xbf80250d,0x3f800000,0xbf80250d,0xbf80250d,0x3f7b3e48,0xbf6dbec4,0x3f553f0e
.long 0x3f800000,0xbf6dbec4,0x3f353f35,0xbec4bf6d,0xbf80250d,0x3f553f0e,0xbec4bf6d,0xbe483f7b
.long 0x3f800000,0xa554bf80,0xbf80250d,0x248d3f80,0xbf80250d,0xbe483f7b,0x3f6d3ec4,0x3f0ebf55
.long 0x3f800000,0x3ec4bf6d,0xbf35bf35,0xbf6d3ec4,0xbf80250d,0xbf0e3f55,0x3ec43f6d,0x3f7b3e48
.long 0x3f800000,0x3f800000,0x3f800000,0x3f800000,0xbf35bf35,0xbf0ebf55,0xbec4bf6d,0xbe48bf7b
.long 0x248d3f80,0xbec43f6d,0xbf353f35,0xbf6d3ec4,0x3f35bf35,0x3f7bbe48,0x3f6d3ec4,0x3f0e3f55
.long 0x3f800000,0x248d3f80,0xbf80250d,0xa554bf80,0xbf35bf35,0x3f55bf0e,0x3ec43f6d,0xbf7b3e48
.long 0x248d3f80,0xbf6dbec4,0x3f35bf35,0x3ec43f6d,0x3f35bf35,0x3e483f7b,0xbf6dbec4,0x3f55bf0e
.long 0x3f800000,0xbf80250d,0x3f800000,0xbf80250d,0xbf35bf35,0x3f0e3f55,0xbec4bf6d,0x3e483f7b
.long 0x248d3f80,0x3ec4bf6d,0xbf353f35,0x3f6dbec4,0x3f35bf35,0xbf7b3e48,0x3f6d3ec4,0xbf0ebf55
.long 0x3f800000,0xa554bf80,0xbf80250d,0x248d3f80,0xbf35bf35,0xbf553f0e,0x3ec43f6d,0x3f7bbe48
.long 0x248d3f80,0x3f6d3ec4,0x3f35bf35,0xbec4bf6d,0x3f35bf35,0xbe48bf7b,0xbf6dbec4,0xbf553f0e
.long 0x3f800000,0x3f800000,0x3f800000,0x3f800000,0xa554bf80,0x3e48bf7b,0x3ec4bf6d,0x3f0ebf55
.long 0xbf80250d,0xbf6dbec4,0xbf35bf35,0xbec4bf6d,0x248d3f80,0xbf0e3f55,0xbf6d3ec4,0xbf7bbe48
.long 0x3f800000,0x248d3f80,0xbf80250d,0xa554bf80,0xa554bf80,0x3f7b3e48,0xbec43f6d,0xbf55bf0e
.long 0xbf80250d,0x3ec4bf6d,0x3f353f35,0xbf6d3ec4,0x248d3f80,0xbf55bf0e,0x3f6dbec4,0xbe483f7b
.long 0x3f800000,0xbf80250d,0x3f800000,0xbf80250d,0xa554bf80,0xbe483f7b,0x3ec4bf6d,0xbf0e3f55
.long 0xbf80250d,0x3f6d3ec4,0xbf35bf35,0x3ec43f6d,0x248d3f80,0x3f0ebf55,0xbf6d3ec4,0x3f7b3e48
.long 0x3f800000,0xa554bf80,0xbf80250d,0x248d3f80,0xa554bf80,0xbf7bbe48,0xbec43f6d,0x3f553f0e
.long 0xbf80250d,0xbec43f6d,0x3f353f35,0x3f6dbec4,0x248d3f80,0x3f553f0e,0x3f6dbec4,0x3e48bf7b
.long 0x3f800000,0x3f800000,0x3f800000,0x3f800000,0x3f35bf35,0x3f55bf0e,0x3f6dbec4,0x3f7bbe48
.long 0xa554bf80,0x3ec4bf6d,0x3f35bf35,0x3f6dbec4,0xbf35bf35,0xbe48bf7b,0x3ec4bf6d,0x3f55bf0e
.long 0x3f800000,0x248d3f80,0xbf80250d,0xa554bf80,0x3f35bf35,0x3f0e3f55,0xbf6d3ec4,0xbe48bf7b
.long 0xa554bf80,0x3f6d3ec4,0xbf353f35,0xbec4bf6d,0xbf35bf35,0x3f7bbe48,0xbec43f6d,0xbf0ebf55
.long 0x3f800000,0xbf80250d,0x3f800000,0xbf80250d,0x3f35bf35,0xbf553f0e,0x3f6dbec4,0xbf7b3e48
.long 0xa554bf80,0xbec43f6d,0x3f35bf35,0xbf6d3ec4,0xbf35bf35,0x3e483f7b,0x3ec4bf6d,0xbf553f0e
.long 0x3f800000,0xa554bf80,0xbf80250d,0x248d3f80,0x3f35bf35,0xbf0ebf55,0xbf6d3ec4,0x3e483f7b
.long 0xa554bf80,0xbf6dbec4,0xbf353f35,0x3ec43f6d,0xbf35bf35,0xbf7b3e48,0xbec43f6d,0x3f0e3f55
.long 0x80003f80,0xbf353f35,0xbf80248d,0xbf35bf35,0x80003f80,0xbf553f0e,0xbf6dbec4,0xbe48bf7b
.long 0x80003f80,0xbf6d3ec4,0xbf35bf35,0x3ec4bf6d,0x80003f80,0xbf7b3e48,0xbec4bf6d,0x3f55bf0e
.long 0x80003f80,0xbf35bf35,0x3f80a554,0xbf353f35,0x80003f80,0xbf0ebf55,0x3f6d3ec4,0xbf7b3e48
.long 0x80003f80,0xbec4bf6d,0x3f353f35,0xbf6dbec4,0x80003f80,0xbe48bf7b,0x3ec43f6d,0xbf0ebf55
.long 0x80003f80,0x3f35bf35,0xbf80248d,0x3f353f35,0x80003f80,0x3f55bf0e,0xbf6dbec4,0x3e483f7b
.long 0x80003f80,0x3f6dbec4,0xbf35bf35,0xbec43f6d,0x80003f80,0x3f7bbe48,0xbec4bf6d,0xbf553f0e
.long 0x80003f80,0x3f353f35,0x3f80a554,0x3f35bf35,0x80003f80,0x3f0e3f55,0x3f6d3ec4,0x3f7bbe48
.long 0x80003f80,0x3ec43f6d,0x3f353f35,0x3f6d3ec4,0x80003f80,0x3e483f7b,0x3ec43f6d,0x3f0e3f55
.long 0xa50dbf80,0x3f35bf35,0x3f80a554,0x3f353f35,0x3f35bf35,0x3f7b3e48,0x3ec43f6d,0xbf0e3f55
.long 0x3f80a554,0x3ec43f6d,0xbf353f35,0xbf6dbec4,0x3f353f35,0xbf0e3f55,0xbf6dbec4,0x3e48bf7b
.long 0xa50dbf80,0x3f353f35,0xbf80248d,0x3f35bf35,0x3f35bf35,0xbe483f7b,0xbec4bf6d,0x3f553f0e
.long 0x3f80a554,0xbf6d3ec4,0x3f35bf35,0xbec43f6d,0x3f353f35,0xbf55bf0e,0x3f6d3ec4,0xbf7bbe48
.long 0xa50dbf80,0xbf353f35,0x3f80a554,0xbf35bf35,0x3f35bf35,0xbf7bbe48,0x3ec43f6d,0x3f0ebf55
.long 0x3f80a554,0xbec4bf6d,0xbf353f35,0x3f6d3ec4,0x3f353f35,0x3f0ebf55,0xbf6dbec4,0xbe483f7b
.long 0xa50dbf80,0xbf35bf35,0xbf80248d,0xbf353f35,0x3f35bf35,0x3e48bf7b,0xbec4bf6d,0xbf55bf0e
.long 0x3f80a554,0x3f6dbec4,0x3f35bf35,0x3ec4bf6d,0x3f353f35,0x3f553f0e,0x3f6d3ec4,0x3f7b3e48
.long 0x80003f80,0xbf353f35,0xbf80248d,0xbf35bf35,0xbf80248d,0xbf0ebf55,0x3ec4bf6d,0x3f7bbe48
.long 0xa50dbf80,0x3f6dbec4,0x3f353f35,0xbec43f6d,0x3f80a554,0x3e483f7b,0xbf6d3ec4,0xbf0ebf55
.long 0x80003f80,0xbf35bf35,0x3f80a554,0xbf353f35,0xbf80248d,0x3f55bf0e,0xbec43f6d,0xbe48bf7b
.long 0xa50dbf80,0x3ec43f6d,0xbf35bf35,0x3f6d3ec4,0x3f80a554,0xbf7b3e48,0x3f6dbec4,0xbf553f0e
.long 0x80003f80,0x3f35bf35,0xbf80248d,0x3f353f35,0xbf80248d,0x3f0e3f55,0x3ec4bf6d,0xbf7b3e48
.long 0xa50dbf80,0xbf6d3ec4,0x3f353f35,0x3ec4bf6d,0x3f80a554,0xbe48bf7b,0xbf6d3ec4,0x3f0e3f55
.long 0x80003f80,0x3f353f35,0x3f80a554,0x3f35bf35,0xbf80248d,0xbf553f0e,0xbec43f6d,0x3e483f7b
.long 0xa50dbf80,0xbec4bf6d,0xbf35bf35,0xbf6dbec4,0x3f80a554,0x3f7bbe48,0x3f6dbec4,0x3f55bf0e
.long 0xa50dbf80,0x3f35bf35,0x3f80a554,0x3f353f35,0x3f353f35,0xbe483f7b,0xbf6d3ec4,0xbf55bf0e
.long 0xbf80248d,0xbec4bf6d,0x3f35bf35,0x3f6d3ec4,0x3f35bf35,0x3f553f0e,0xbec43f6d,0xbf7bbe48
.long 0xa50dbf80,0x3f353f35,0xbf80248d,0x3f35bf35,0x3f353f35,0xbf7bbe48,0x3f6dbec4,0xbf0e3f55
.long 0xbf80248d,0x3f6dbec4,0xbf353f35,0x3ec4bf6d,0x3f35bf35,0xbf0e3f55,0x3ec4bf6d,0xbe483f7b
.long 0xa50dbf80,0xbf353f35,0x3f80a554,0xbf35bf35,0x3f353f35,0x3e48bf7b,0xbf6d3ec4,0x3f553f0e
.long 0xbf80248d,0x3ec43f6d,0x3f35bf35,0xbf6dbec4,0x3f35bf35,0xbf55bf0e,0xbec43f6d,0x3f7b3e48
.long 0xa50dbf80,0xbf35bf35,0xbf80248d,0xbf353f35,0x3f353f35,0x3f7b3e48,0x3f6dbec4,0x3f0ebf55
.long 0xbf80248d,0xbf6d3ec4,0xbf353f35,0xbec43f6d,0x3f35bf35,0x3f0ebf55,0x3ec4bf6d,0x3e48bf7b
.long 0x3f800000,0x3f353f35,0x248d3f80,0xbf353f35,0x3f800000,0x3f0e3f55,0xbec43f6d,0xbf7b3e48
.long 0x3f800000,0x3ec43f6d,0xbf353f35,0xbf6dbec4,0x3f800000,0x3e483f7b,0xbf6d3ec4,0xbf0ebf55
.long 0x3f800000,0xbf353f35,0xa554bf80,0x3f353f35,0x3f800000,0xbf553f0e,0x3ec4bf6d,0x3e483f7b
.long 0x3f800000,0xbf6d3ec4,0x3f35bf35,0xbec43f6d,0x3f800000,0xbf7b3e48,0x3f6dbec4,0xbf553f0e
.long 0x3f800000,0xbf35bf35,0x248d3f80,0x3f35bf35,0x3f800000,0xbf0ebf55,0xbec43f6d,0x3f7bbe48
.long 0x3f800000,0xbec4bf6d,0xbf353f35,0x3f6d3ec4,0x3f800000,0xbe48bf7b,0xbf6d3ec4,0x3f0e3f55
.long 0x3f800000,0x3f35bf35,0xa554bf80,0xbf35bf35,0x3f800000,0x3f55bf0e,0x3ec4bf6d,0xbe48bf7b
.long 0x3f800000,0x3f6dbec4,0x3f35bf35,0x3ec4bf6d,0x3f800000,0x3f7bbe48,0x3f6dbec4,0x3f55bf0e
.long 0xbf80250d,0xbf35bf35,0xa554bf80,0x3f35bf35,0xbf35bf35,0x3e48bf7b,0x3f6dbec4,0x3f553f0e
.long 0xa554bf80,0x3f6dbec4,0x3f353f35,0xbec43f6d,0x3f35bf35,0x3f553f0e,0xbec43f6d,0xbf7bbe48
.long 0xbf80250d,0x3f35bf35,0x248d3f80,0xbf35bf35,0xbf35bf35,0x3f7b3e48,0xbf6d3ec4,0x3f0ebf55
.long 0xa554bf80,0x3ec43f6d,0xbf35bf35,0x3f6d3ec4,0x3f35bf35,0xbf0e3f55,0x3ec4bf6d,0xbe483f7b
.long 0xbf80250d,0x3f353f35,0xa554bf80,0xbf353f35,0xbf35bf35,0xbe483f7b,0x3f6dbec4,0xbf55bf0e
.long 0xa554bf80,0xbf6d3ec4,0x3f353f35,0x3ec4bf6d,0x3f35bf35,0xbf55bf0e,0xbec43f6d,0x3f7b3e48
.long 0xbf80250d,0xbf353f35,0x248d3f80,0x3f353f35,0xbf35bf35,0xbf7bbe48,0xbf6d3ec4,0xbf0e3f55
.long 0xa554bf80,0xbec4bf6d,0xbf35bf35,0xbf6dbec4,0x3f35bf35,0x3f0ebf55,0x3ec4bf6d,0x3e48bf7b
.long 0x3f800000,0x3f353f35,0x248d3f80,0xbf353f35,0x248d3f80,0xbf553f0e,0xbf6dbec4,0xbe48bf7b
.long 0xbf80250d,0xbec4bf6d,0x3f35bf35,0x3f6d3ec4,0xa554bf80,0x3f7bbe48,0x3ec43f6d,0xbf553f0e
.long 0x3f800000,0xbf353f35,0xa554bf80,0x3f353f35,0x248d3f80,0xbf0ebf55,0x3f6d3ec4,0xbf7b3e48
.long 0xbf80250d,0x3f6dbec4,0xbf353f35,0x3ec4bf6d,0xa554bf80,0x3e483f7b,0xbec4bf6d,0x3f0e3f55
.long 0x3f800000,0xbf35bf35,0x248d3f80,0x3f35bf35,0x248d3f80,0x3f55bf0e,0xbf6dbec4,0x3e483f7b
.long 0xbf80250d,0x3ec43f6d,0x3f35bf35,0xbf6dbec4,0xa554bf80,0xbf7b3e48,0x3ec43f6d,0x3f55bf0e
.long 0x3f800000,0x3f35bf35,0xa554bf80,0xbf35bf35,0x248d3f80,0x3f0e3f55,0x3f6d3ec4,0x3f7bbe48
.long 0xbf80250d,0xbf6d3ec4,0xbf353f35,0xbec43f6d,0xa554bf80,0xbe48bf7b,0xbec4bf6d,0xbf0ebf55
.long 0xbf80250d,0xbf35bf35,0xa554bf80,0x3f35bf35,0x3f35bf35,0x3f7b3e48,0x3ec43f6d,0xbf0e3f55
.long 0x248d3f80,0xbf6d3ec4,0xbf35bf35,0x3ec4bf6d,0xbf35bf35,0x3f0ebf55,0x3f6d3ec4,0xbe483f7b
.long 0xbf80250d,0x3f35bf35,0x248d3f80,0xbf35bf35,0x3f35bf35,0xbe483f7b,0xbec4bf6d,0x3f553f0e
.long 0x248d3f80,0xbec4bf6d,0x3f353f35,0xbf6dbec4,0xbf35bf35,0x3f553f0e,0xbf6dbec4,0x3f7b3e48
.long 0xbf80250d,0x3f353f35,0xa554bf80,0xbf353f35,0x3f35bf35,0xbf7bbe48,0x3ec43f6d,0x3f0ebf55
.long 0x248d3f80,0x3f6dbec4,0xbf35bf35,0xbec43f6d,0xbf35bf35,0xbf0e3f55,0x3f6d3ec4,0x3e48bf7b
.long 0xbf80250d,0xbf353f35,0x248d3f80,0x3f353f35,0x3f35bf35,0x3e48bf7b,0xbec4bf6d,0xbf55bf0e
.long 0x248d3f80,0x3ec43f6d,0x3f353f35,0x3f6d3ec4,0xbf35bf35,0xbf55bf0e,0xbf6dbec4,0xbf7bbe48
.long 0x80003f80,0xbf353f35,0xbf80248d,0xbf35bf35,0xa50dbf80,0x3f55bf0e,0x3f6d3ec4,0x3e483f7b
.long 0x80003f80,0xbf6d3ec4,0xbf35bf35,0x3ec4bf6d,0xa50dbf80,0x3f7bbe48,0x3ec43f6d,0xbf553f0e
.long 0x80003f80,0xbf35bf35,0x3f80a554,0xbf353f35,0xa50dbf80,0x3f0e3f55,0xbf6dbec4,0x3f7bbe48
.long 0x80003f80,0xbec4bf6d,0x3f353f35,0xbf6dbec4,0xa50dbf80,0x3e483f7b,0xbec4bf6d,0x3f0e3f55
.long 0x80003f80,0x3f35bf35,0xbf80248d,0x3f353f35,0xa50dbf80,0xbf553f0e,0x3f6d3ec4,0xbe48bf7b
.long 0x80003f80,0x3f6dbec4,0xbf35bf35,0xbec43f6d,0xa50dbf80,0xbf7b3e48,0x3ec43f6d,0x3f55bf0e
.long 0x80003f80,0x3f353f35,0x3f80a554,0x3f35bf35,0xa50dbf80,0xbf0ebf55,0xbf6dbec4,0xbf7b3e48
.long 0x80003f80,0x3ec43f6d,0x3f353f35,0x3f6d3ec4,0xa50dbf80,0xbe48bf7b,0xbec4bf6d,0xbf0ebf55
.long 0xa50dbf80,0x3f35bf35,0x3f80a554,0x3f353f35,0xbf353f35,0xbf7bbe48,0xbec4bf6d,0x3f0ebf55
.long 0x3f80a554,0x3ec43f6d,0xbf353f35,0xbf6dbec4,0xbf35bf35,0x3f0ebf55,0x3f6d3ec4,0xbe483f7b
.long 0xa50dbf80,0x3f353f35,0xbf80248d,0x3f35bf35,0xbf353f35,0x3e48bf7b,0x3ec43f6d,0xbf55bf0e
.long 0x3f80a554,0xbf6d3ec4,0x3f35bf35,0xbec43f6d,0xbf35bf35,0x3f553f0e,0xbf6dbec4,0x3f7b3e48
.long 0xa50dbf80,0xbf353f35,0x3f80a554,0xbf35bf35,0xbf353f35,0x3f7b3e48,0xbec4bf6d,0xbf0e3f55
.long 0x3f80a554,0xbec4bf6d,0xbf353f35,0x3f6d3ec4,0xbf35bf35,0xbf0e3f55,0x3f6d3ec4,0x3e48bf7b
.long 0xa50dbf80,0xbf35bf35,0xbf80248d,0xbf353f35,0xbf353f35,0xbe483f7b,0x3ec43f6d,0x3f553f0e
.long 0x3f80a554,0x3f6dbec4,0x3f35bf35,0x3ec4bf6d,0xbf35bf35,0xbf55bf0e,0xbf6dbec4,0xbf7bbe48
.long 0x80003f80,0xbf353f35,0xbf80248d,0xbf35bf35,0x3f80a554,0x3f0e3f55,0xbec43f6d,0xbf7b3e48
.long 0xa50dbf80,0x3f6dbec4,0x3f353f35,0xbec43f6d,0xbf80248d,0xbe48bf7b,0x3f6dbec4,0x3f0e3f55
.long 0x80003f80,0xbf35bf35,0x3f80a554,0xbf353f35,0x3f80a554,0xbf553f0e,0x3ec4bf6d,0x3e483f7b
.long 0xa50dbf80,0x3ec43f6d,0xbf35bf35,0x3f6d3ec4,0xbf80248d,0x3f7bbe48,0xbf6d3ec4,0x3f55bf0e
.long 0x80003f80,0x3f35bf35,0xbf80248d,0x3f353f35,0x3f80a554,0xbf0ebf55,0xbec43f6d,0x3f7bbe48
.long 0xa50dbf80,0xbf6d3ec4,0x3f353f35,0x3ec4bf6d,0xbf80248d,0x3e483f7b,0x3f6dbec4,0xbf0ebf55
.long 0x80003f80,0x3f353f35,0x3f80a554,0x3f35bf35,0x3f80a554,0x3f55bf0e,0x3ec4bf6d,0xbe48bf7b
.long 0xa50dbf80,0xbec4bf6d,0xbf35bf35,0xbf6dbec4,0xbf80248d,0xbf7b3e48,0xbf6d3ec4,0xbf553f0e
.long 0xa50dbf80,0x3f35bf35,0x3f80a554,0x3f353f35,0xbf35bf35,0x3e48bf7b,0x3f6dbec4,0x3f553f0e
.long 0xbf80248d,0xbec4bf6d,0x3f35bf35,0x3f6d3ec4,0xbf353f35,0xbf55bf0e,0x3ec4bf6d,0x3f7b3e48
.long 0xa50dbf80,0x3f353f35,0xbf80248d,0x3f35bf35,0xbf35bf35,0x3f7b3e48,0xbf6d3ec4,0x3f0ebf55
.long 0xbf80248d,0x3f6dbec4,0xbf353f35,0x3ec4bf6d,0xbf353f35,0x3f0ebf55,0xbec43f6d,0x3e48bf7b
.long 0xa50dbf80,0xbf353f35,0x3f80a554,0xbf35bf35,0xbf35bf35,0xbe483f7b,0x3f6dbec4,0xbf55bf0e
.long 0xbf80248d,0x3ec43f6d,0x3f35bf35,0xbf6dbec4,0xbf353f35,0x3f553f0e,0x3ec4bf6d,0xbf7bbe48
.long 0xa50dbf80,0xbf35bf35,0xbf80248d,0xbf353f35,0xbf35bf35,0xbf7bbe48,0xbf6d3ec4,0xbf0e3f55
.long 0xbf80248d,0xbf6d3ec4,0xbf353f35,0xbec43f6d,0xbf353f35,0xbf0e3f55,0xbec43f6d,0xbe483f7b
.long 0x3f800000,0x3f353f35,0x248d3f80,0xbf353f35,0xbf80250d,0xbf0ebf55,0x3ec4bf6d,0x3f7bbe48
.long 0x3f800000,0x3ec43f6d,0xbf353f35,0xbf6dbec4,0xbf80250d,0xbe48bf7b,0x3f6dbec4,0x3f0e3f55
.long 0x3f800000,0xbf353f35,0xa554bf80,0x3f353f35,0xbf80250d,0x3f55bf0e,0xbec43f6d,0xbe48bf7b
.long 0x3f800000,0xbf6d3ec4,0x3f35bf35,0xbec43f6d,0xbf80250d,0x3f7bbe48,0xbf6d3ec4,0x3f55bf0e
.long 0x3f800000,0xbf35bf35,0x248d3f80,0x3f35bf35,0xbf80250d,0x3f0e3f55,0x3ec4bf6d,0xbf7b3e48
.long 0x3f800000,0xbec4bf6d,0xbf353f35,0x3f6d3ec4,0xbf80250d,0x3e483f7b,0x3f6dbec4,0xbf0ebf55
.long 0x3f800000,0x3f35bf35,0xa554bf80,0xbf35bf35,0xbf80250d,0xbf553f0e,0xbec43f6d,0x3e483f7b
.long 0x3f800000,0x3f6dbec4,0x3f35bf35,0x3ec4bf6d,0xbf80250d,0xbf7b3e48,0xbf6d3ec4,0xbf553f0e
.long 0xbf80250d,0xbf35bf35,0xa554bf80,0x3f35bf35,0x3f353f35,0xbe483f7b,0xbf6d3ec4,0xbf55bf0e
.long 0xa554bf80,0x3f6dbec4,0x3f353f35,0xbec43f6d,0xbf353f35,0xbf55bf0e,0x3ec4bf6d,0x3f7b3e48
.long 0xbf80250d,0x3f35bf35,0x248d3f80,0xbf35bf35,0x3f353f35,0xbf7bbe48,0x3f6dbec4,0xbf0e3f55
.long 0xa554bf80,0x3ec43f6d,0xbf35bf35,0x3f6d3ec4,0xbf353f35,0x3f0ebf55,0xbec43f6d,0x3e48bf7b
.long 0xbf80250d,0x3f353f35,0xa554bf80,0xbf353f35,0x3f353f35,0x3e48bf7b,0xbf6d3ec4,0x3f553f0e
.long 0xa554bf80,0xbf6d3ec4,0x3f353f35,0x3ec4bf6d,0xbf353f35,0x3f553f0e,0x3ec4bf6d,0xbf7bbe48
.long 0xbf80250d,0xbf353f35,0x248d3f80,0x3f353f35,0x3f353f35,0x3f7b3e48,0x3f6dbec4,0x3f0ebf55
.long 0xa554bf80,0xbec4bf6d,0xbf35bf35,0xbf6dbec4,0xbf353f35,0xbf0e3f55,0xbec43f6d,0xbe483f7b
.long 0x3f800000,0x3f353f35,0x248d3f80,0xbf353f35,0xa554bf80,0x3f55bf0e,0x3f6d3ec4,0x3e483f7b
.long 0xbf80250d,0xbec4bf6d,0x3f35bf35,0x3f6d3ec4,0x248d3f80,0xbf7b3e48,0xbec4bf6d,0x3f55bf0e
.long 0x3f800000,0xbf353f35,0xa554bf80,0x3f353f35,0xa554bf80,0x3f0e3f55,0xbf6dbec4,0x3f7bbe48
.long 0xbf80250d,0x3f6dbec4,0xbf353f35,0x3ec4bf6d,0x248d3f80,0xbe48bf7b,0x3ec43f6d,0xbf0ebf55
.long 0x3f800000,0xbf35bf35,0x248d3f80,0x3f35bf35,0xa554bf80,0xbf553f0e,0x3f6d3ec4,0xbe48bf7b
.long 0xbf80250d,0x3ec43f6d,0x3f35bf35,0xbf6dbec4,0x248d3f80,0x3f7bbe48,0xbec4bf6d,0xbf553f0e
.long 0x3f800000,0x3f35bf35,0xa554bf80,0xbf35bf35,0xa554bf80,0xbf0ebf55,0xbf6dbec4,0xbf7b3e48
.long 0xbf80250d,0xbf6d3ec4,0xbf353f35,0xbec43f6d,0x248d3f80,0x3e483f7b,0x3ec43f6d,0x3f0e3f55
.long 0xbf80250d,0xbf35bf35,0xa554bf80,0x3f35bf35,0xbf353f35,0xbf7bbe48,0xbec4bf6d,0x3f0ebf55
.long 0x248d3f80,0xbf6d3ec4,0xbf35bf35,0x3ec4bf6d,0x3f353f35,0xbf0e3f55,0xbf6dbec4,0x3e48bf7b
.long 0xbf80250d,0x3f35bf35,0x248d3f80,0xbf35bf35,0xbf353f35,0x3e48bf7b,0x3ec43f6d,0xbf55bf0e
.long 0x248d3f80,0xbec4bf6d,0x3f353f35,0xbf6dbec4,0x3f353f35,0xbf55bf0e,0x3f6d3ec4,0xbf7bbe48
.long 0xbf80250d,0x3f353f35,0xa554bf80,0xbf353f35,0xbf353f35,0x3f7b3e48,0xbec4bf6d,0xbf0e3f55
.long 0x248d3f80,0x3f6dbec4,0xbf35bf35,0xbec43f6d,0x3f353f35,0x3f0ebf55,0xbf6dbec4,0xbe483f7b
.long 0xbf80250d,0xbf353f35,0x248d3f80,0x3f353f35,0xbf353f35,0xbe483f7b,0x3ec43f6d,0x3f553f0e
.long 0x248d3f80,0x3ec43f6d,0x3f353f35,0x3f6d3ec4,0x3f353f35,0x3f553f0e,0x3f6d3ec4,0x3f7b3e48
.long 0x354ccccd,0x35cccccd,0x35cccccd,0x35cccccd,0x354ccccd,0x35ccca46,0x35ccc2b2,0x35ccb610
.long 0x354ccccd,0x35ccc2b2,0x35cca461,0x35cc71de,0x354ccccd,0x35ccb610,0x35cc71de,0x35cc0047
.long 0x354ccccd,0x35cc2b2e,0x35ca4751,0x35c72430,0x354ccccd,0x35cc0047,0x35c99c4e,0x35c5a5a8
.long 0x354ccccd,0x35cbd057,0x35c8dd65,0x35c3fb3c,0x354ccccd,0x35cb9b60,0x35c80aaa,0x35c2254b
.long 0x354ccccd,0x35ca4751,0x35c2c6c0,0x35b67a67,0x354ccccd,0x35c9f44d,0x35c17f0c,0x35b3a936
.long 0x354ccccd,0x35c99c4e,0x35c0243f,0x35b0b021,0x354ccccd,0x35c93f55,0x35beb67b,0x35ad8fd0
.long 0x354ccccd,0x35c72430,0x35b67a67,0x359bbb2c,0x354ccccd,0x35c6a993,0x35b49e13,0x3597bf2e
.long 0x354ccccd,0x35c62a0f,0x35b2afeb,0x3593a17d,0x354ccccd,0x35c5a5a8,0x35b0b021,0x358f6305
.long 0x35cccccd,0x35cccccd,0x35cccccd,0x35cccccd,0x35cca461,0x35cc8da6,0x35cc71de,0x35cc510b
.long 0x35cc2b2e,0x35cbd057,0x35cb6163,0x35cade5d,0x35cb6163,0x35ca9556,0x35c99c4e,0x35c87681
.long 0x35c2c6c0,0x35bd35e5,0x35b67a67,0x35ae9ee7,0x35c0243f,0x35b92313,0x35b0b021,0x35a6dc49
.long 0x35bd35e5,0x35b49e13,0x35aa48f4,0x359e5003,0x35b9fcdb,0x35afa9af,0x35a34a91,0x35950468
.long 0x35a5afca,0x3590d0c3,0x3570c1c0,0x3539f45b,0x35a0d539,0x35898908,0x355cd4c0,0x35207465
.long 0x359bbb2c,0x3581ec7b,0x354823a7,0x35063284,0x359663a6,0x3573ff99,0x3532c0d3,0x34d69ce7
.long 0x3570c1c0,0x351cbf44,0x348026af,0xb4008c21,0x35638fc3,0x3509fd76,0x3420975e,0xb4706739
.long 0x355603f2,0x34edcd1c,0x3380a585,0xb4af8fe3,0x354823a7,0x34c70ca3,0xb300abdf,0xb4e617fd
.long 0x35cccccd,0x35cccccd,0x354ccccd,0x0,0x35cc2b2e,0x35cc0047,0x354bd057,0x0
.long 0x35ca4751,0x35c99c4e,0x3548dd65,0x0,0x35c72430,0x35c5a5a8,0x3543fb3c,0x0
.long 0x35a5afca,0x359bbb2c,0x3510d0c3,0x0,0x359bbb2c,0x358f6305,0x3501ec7b,0x0
.long 0x3590d0c3,0x3581ec7b,0x34e38fc3,0x0,0x358501c8,0x3566e4e3,0x34c11588,0x0
.long 0x34fd2590,0x348026af,0x1a61e84f,0x80000000,0x34bf3d0b,0x33e1031c,0xb3a0975e,0x80000000
.long 0x348026af,0xb300abdf,0xb41fd168,0x80000000,0x34008c21,0xb430973e,0xb46dcd1c,0x80000000
.long 0xb4fd2590,0xb55603f2,0xb510d0c3,0x80000000,0xb51cbf44,0xb573ff99,0xb51e5003,0x80000000
.long 0xb539f45b,0xb58809f5,0xb52a48f4,0x80000000,0xb55603f2,0xb5950468,0xb5349e13,0x80000000
.long 0x0,0x0,0x0,0x0,0x0,0x0,0x0,0x0
.long 0x0,0x0,0x0,0x0,0x0,0x0,0x0,0x0
.long 0x0,0x0,0x0,0x0,0x0,0x0,0x0,0x0
.long 0x0,0x0,0x0,0x0,0x0,0x0,0x0,0x80000000
.long 0x80000000,0x80000000,0x80000000,0x80000000,0x80000000,0x80000000,0x80000000,0x80000000
.long 0x80000000,0x80000000,0x80000000,0x80000000,0x80000000,0x80000000,0x80000000,0x80000000
.long 0x80000000,0x80000000,0x80000000,0x80000000,0x80000000,0x80000000,0x80000000,0x80000000
.long 0x80000000,0x80000000,0x80000000,0x80000000,0x80000000,0x80000000,0x80000000,0x80000000
.long 0x354ccccd,0x35cca461,0x35cc2b2e,0x35cb6163,0x354ccccd,0x35cc8da6,0x35cbd057,0x35ca9556
.long 0x354ccccd,0x35cc71de,0x35cb6163,0x35c99c4e,0x354ccccd,0x35cc510b,0x35cade5d,0x35c87681
.long 0x354ccccd,0x35cb6163,0x35c72430,0x35c0243f,0x354ccccd,0x35cb2261,0x35c62a0f,0x35bdf888
.long 0x354ccccd,0x35cade5d,0x35c51c60,0x35bba2a3,0x354ccccd,0x35ca9556,0x35c3fb3c,0x35b92313
.long 0x354ccccd,0x35c8dd65,0x35bd35e5,0x35aa48f4,0x354ccccd,0x35c87681,0x35bba2a3,0x35a6dc49
.long 0x354ccccd,0x35c80aaa,0x35b9fcdb,0x35a34a91,0x354ccccd,0x35c799e3,0x35b844b9,0x359f9496
.long 0x354ccccd,0x35c51c60,0x35ae9ee7,0x358b04b5,0x354ccccd,0x35c48e3a,0x35ac7c70,0x35868788
.long 0x354ccccd,0x35c3fb3c,0x35aa48f4,0x3581ec7b,0x354ccccd,0x35c36367,0x35a804aa,0x357a6928
.long 0x35ca4751,0x35c8dd65,0x35c72430,0x35c51c60,0x35c8dd65,0x35c6a993,0x35c3fb3c,0x35c0d407
.long 0x35c72430,0x35c3fb3c,0x35c0243f,0x35bba2a3,0x35c51c60,0x35c0d407,0x35bba2a3,0x35b58e7a
.long 0x35b67a67,0x35aa48f4,0x359bbb2c,0x358b04b5,0x35b2afeb,0x35a47f35,0x3593a17d,0x35805d00
.long 0x35ae9ee7,0x359e5003,0x358b04b5,0x356a3450,0x35aa48f4,0x3597bf2e,0x3581ec7b,0x35529394
.long 0x3590d0c3,0x35638fc3,0x351cbf44,0x349fd168,0x358b04b5,0x35529394,0x35063284,0x34508986
.long 0x358501c8,0x35411588,0x34de5d30,0x33c0e869,0x357d94b5,0x352f2067,0x34af8fe3,0xb280ad75
.long 0x3539f45b,0x349fd168,0xb4008c21,0xb50dc501,0x352b7ba8,0x34706739,0xb4607b24,0xb527d2ae
.long 0x351cbf44,0x3420975e,0xb49fd168,0xb5411588,0x350dc501,0x33a0c8f3,0xb4ced752,0xb5596f08
.long 0x35c2c6c0,0x35c0243f,0x353d35e5,0x0,0x35bd35e5,0x35b92313,0x35349e13,0x0
.long 0x35b67a67,0x35b0b021,0x352a48f4,0x0,0x35ae9ee7,0x35a6dc49,0x351e5003,0x0
.long 0x3570c1c0,0x354823a7,0x349cbf44,0x0,0x355603f2,0x3527d2ae,0x346dcd1c,0x0
.long 0x3539f45b,0x35063284,0x341fd168,0x0,0x351cbf44,0x34c70ca3,0x33a0975e,0x80000000
.long 0x1ae1e84f,0xb49fd168,0xb49cbf44,0x80000000,0xb4008c21,0xb4e617fd,0xb4c11588,0x80000000
.long 0xb48026af,0xb5154980,0xb4e38fc3,0x80000000,0xb4bf3d0b,0xb5365cd7,0xb501ec7b,0x80000000
.long 0xb570c1c0,0xb5a0d539,0xb53d35e5,0x80000000,0xb58501c8,0xb5ab64d0,0xb543fb3c,0x80000000
.long 0xb590d0c3,0xb5b49e13,0xb548dd65,0x80000000,0xb59bbb2c,0xb5bc6e97,0xb54bd057,0x80000000
.long 0x0,0x0,0x0,0x0,0x0,0x0,0x0,0x0
.long 0x0,0x0,0x0,0x0,0x0,0x0,0x0,0x0
.long 0x0,0x0,0x80000000,0x80000000,0x0,0x80000000,0x80000000,0x80000000
.long 0x80000000,0x80000000,0x80000000,0x80000000,0x80000000,0x80000000,0x80000000,0x80000000
.long 0x80000000,0x80000000,0x80000000,0x80000000,0x80000000,0x80000000,0x80000000,0x80000000
.long 0x80000000,0x80000000,0x80000000,0x80000000,0x80000000,0x80000000,0x80000000,0x80000000
.long 0x80000000,0x80000000,0x80000000,0x80000000,0x80000000,0x80000000,0x80000000,0x80000000
.long 0x80000000,0x80000000,0x80000000,0x80000000,0x80000000,0x80000000,0x80000000,0x80000000
.long 0x0,0x0,0x0,0x0,0x0,0x3280ad75,0x3300abdf,0x3340fdd6
.long 0x0,0x3300abdf,0x3380a585,0x33c0e869,0x0,0x3340fdd6,0x33c0e869,0x34109388
.long 0x0,0x34008c21,0x348026af,0x34bf3d0b,0x0,0x34109388,0x34900327,0x34d69ce7
.long 0x0,0x3420975e,0x349fd168,0x34edcd1c,0x0,0x3430973e,0x34af8fe3,0x35026442
.long 0x0,0x348026af,0x34fd2590,0x3539f45b,0x0,0x34881699,0x35063284,0x35449f04
.long 0x0,0x34900327,0x350dc501,0x354f1e05,0x0,0x3497ec27,0x35154980,0x35596f08
.long 0x0,0x34bf3d0b,0x3539f45b,0x358501c8,0x0,0x34c70ca3,0x35411588,0x35898908
.long 0x0,0x34ced752,0x354823a7,0x358df1bd,0x0,0x34d69ce7,0x354f1e05,0x35923aee
.long 0x0,0x0,0x0,0x0,0x3380a585,0x33a0c8f3,0x33c0e869,0x33e1031c
.long 0x34008c21,0x3420975e,0x344092c2,0x34607b24,0x344092c2,0x34706739,0x34900327,0x34a7b2b7
.long 0x34fd2590,0x351cbf44,0x3539f45b,0x355603f2,0x350dc501,0x352f2067,0x354f1e05,0x356d7df6
.long 0x351cbf44,0x35411588,0x35638fc3,0x3581ec7b,0x352b7ba8,0x35529394,0x3577376d,0x358c7cf5
.long 0x3570c1c0,0x3590d0c3,0x35a5afca,0x35b67a67,0x357d94b5,0x3597bf2e,0x35ac7c70,0x35bc6e97
.long 0x358501c8,0x359e5003,0x35b2afeb,0x35c17f0c,0x358b04b5,0x35a47f35,0x35b844b9,0x35c5a5a8
.long 0x35a5afca,0x35bd35e5,0x35ca4751,0x35cc2b2e,0x35aa48f4,0x35c0d407,0x35cbd057,0x35ca9556
.long 0x35ae9ee7,0x35c3fb3c,0x35cca461,0x35c80aaa,0x35b2afeb,0x35c6a993,0x35ccc2b2,0x35c48e3a
.long 0x0,0x0,0x0,0x0,0x34008c21,0x34109388,0x33a0975e,0x0
.long 0x348026af,0x34900327,0x341fd168,0x0,0x34bf3d0b,0x34d69ce7,0x346dcd1c,0x0
.long 0x3570c1c0,0x358501c8,0x3510d0c3,0x0,0x358501c8,0x35923aee,0x351e5003,0x0
.long 0x3590d0c3,0x359e5003,0x352a48f4,0x0,0x359bbb2c,0x35a928e5,0x35349e13,0x0
.long 0x35c2c6c0,0x35ca4751,0x354ccccd,0x0,0x35c72430,0x35cc510b,0x354bd057,0x0
.long 0x35ca4751,0x35ccc2b2,0x3548dd65,0x0,0x35cc2b2e,0x35cb9b60,0x3543fb3c,0x0
.long 0x35c2c6c0,0x35ae9ee7,0x3510d0c3,0x0,0x35bd35e5,0x35a47f35,0x3501ec7b,0x0
.long 0x35b67a67,0x359916f7,0x34e38fc3,0x0,0x35ae9ee7,0x358c7cf5,0x34c11588,0x0
.long 0x0,0x0,0x0,0x0,0x0,0x0,0x0,0x0
.long 0x0,0x0,0x0,0x0,0x0,0x0,0x0,0x0
.long 0x0,0x0,0x0,0x0,0x0,0x0,0x0,0x0
.long 0x0,0x0,0x0,0x0,0x0,0x0,0x0,0x0
.long 0x0,0x0,0x0,0x0,0x0,0x0,0x0,0x0
.long 0x0,0x0,0x0,0x0,0x0,0x0,0x0,0x0
.long 0x0,0x0,0x80000000,0x80000000,0x0,0x80000000,0x80000000,0x80000000
.long 0x0,0x80000000,0x80000000,0x80000000,0x80000000,0x80000000,0x80000000,0x80000000
.long 0x0,0x3380a585,0x34008c21,0x344092c2,0x0,0x33a0c8f3,0x3420975e,0x34706739
.long 0x0,0x33c0e869,0x344092c2,0x34900327,0x0,0x33e1031c,0x34607b24,0x34a7b2b7
.long 0x0,0x344092c2,0x34bf3d0b,0x350dc501,0x0,0x34508986,0x34ced752,0x35190646
.long 0x0,0x34607b24,0x34de5d30,0x35242590,0x0,0x34706739,0x34edcd1c,0x352f2067
.long 0x0,0x349fd168,0x351cbf44,0x35638fc3,0x0,0x34a7b2b7,0x35242590,0x356d7df6
.long 0x0,0x34af8fe3,0x352b7ba8,0x3577376d,0x0,0x34b768ba,0x3532c0d3,0x35805d00
.long 0x0,0x34de5d30,0x355603f2,0x359663a6,0x0,0x34e617fd,0x355cd4c0,0x359a6af9
.long 0x0,0x34edcd1c,0x35638fc3,0x359e5003,0x0,0x34f57c5d,0x356a3450,0x35a211e5
.long 0x348026af,0x349fd168,0x34bf3d0b,0x34de5d30,0x349fd168,0x34c70ca3,0x34edcd1c,0x3509fd76
.long 0x34bf3d0b,0x34edcd1c,0x350dc501,0x35242590,0x34de5d30,0x3509fd76,0x35242590,0x353d8748
.long 0x3539f45b,0x35638fc3,0x358501c8,0x359663a6,0x354823a7,0x3573ff99,0x358df1bd,0x359f9496
.long 0x355603f2,0x3581ec7b,0x359663a6,0x35a804aa,0x35638fc3,0x35898908,0x359e5003,0x35afa9af
.long 0x3590d0c3,0x35aa48f4,0x35bd35e5,0x35c8dd65,0x359663a6,0x35afa9af,0x35c17f0c,0x35cb2261
.long 0x359bbb2c,0x35b49e13,0x35c51c60,0x35cc71de,0x35a0d539,0x35b92313,0x35c80aaa,0x35ccca46
.long 0x35b67a67,0x35c8dd65,0x35cc2b2e,0x35c0243f,0x35b9fcdb,0x35ca9556,0x35cade5d,0x35bad20d
.long 0x35bd35e5,0x35cbd057,0x35c8dd65,0x35b49e13,0x35c0243f,0x35cc8da6,0x35c62a0f,0x35ad8fd0
.long 0x34fd2590,0x350dc501,0x349cbf44,0x0,0x351cbf44,0x352f2067,0x34c11588,0x0
.long 0x3539f45b,0x354f1e05,0x34e38fc3,0x0,0x355603f2,0x356d7df6,0x3501ec7b,0x0
.long 0x35a5afca,0x35b2afeb,0x353d35e5,0x0,0x35ae9ee7,0x35bad20d,0x3543fb3c,0x0
.long 0x35b67a67,0x35c17f0c,0x3548dd65,0x0,0x35bd35e5,0x35c6a993,0x354bd057,0x0
.long 0x35cccccd,0x35c8dd65,0x353d35e5,0x0,0x35cc2b2e,0x35c48e3a,0x35349e13,0x0
.long 0x35ca4751,0x35beb67b,0x352a48f4,0x0,0x35c72430,0x35b761d3,0x351e5003,0x0
.long 0x35a5afca,0x357d94b5,0x349cbf44,0x0,0x359bbb2c,0x35603506,0x346dcd1c,0x0
.long 0x3590d0c3,0x35411588,0x341fd168,0x80000000,0x358501c8,0x35207465,0x33a0975e,0x80000000
.long 0x0,0x0,0x0,0x0,0x0,0x0,0x0,0x0
.long 0x0,0x0,0x0,0x0,0x0,0x0,0x0,0x0
.long 0x0,0x0,0x0,0x0,0x0,0x0,0x0,0x0
.long 0x0,0x0,0x0,0x0,0x0,0x0,0x0,0x0
.long 0x0,0x0,0x0,0x0,0x0,0x0,0x0,0x0
.long 0x0,0x0,0x0,0x80000000,0x0,0x0,0x80000000,0x80000000
.long 0x80000000,0x80000000,0x80000000,0x80000000,0x80000000,0x80000000,0x80000000,0x80000000
.long 0x80000000,0x80000000,0x80000000,0x80000000,0x80000000,0x80000000,0x80000000,0x80000000
.long 0x80003f80,0x80003f80,0x80003f80,0x80003f80,0x80003f80,0xbe9e3f73,0xbf163f4f,0xbf4f3f16
.long 0x80003f80,0xbf163f4f,0xbf733e9e,0xbf73be9e,0x80003f80,0xbf4f3f16,0xbf73be9e,0xbe9ebf73
.long 0x80003f80,0xbf733e9e,0xbf16bf4f,0x3f16bf4f,0x80003f80,0xbf80248d,0xa50dbf80,0x3f80a554
.long 0x80003f80,0xbf73be9e,0x3f16bf4f,0x3f163f4f,0x80003f80,0xbf4fbf16,0x3f73be9e,0xbe9e3f73
.long 0x80003f80,0xbf16bf4f,0x3f733e9e,0xbf733e9e,0x80003f80,0xbe9ebf73,0x3f163f4f,0xbf4fbf16
.long 0x80003f80,0xa50dbf80,0x80003f80,0xa50dbf80,0x80003f80,0x3e9ebf73,0xbf163f4f,0x3f4fbf16
.long 0x80003f80,0x3f16bf4f,0xbf733e9e,0x3f733e9e,0x80003f80,0x3f4fbf16,0xbf73be9e,0x3e9e3f73
.long 0x80003f80,0x3f73be9e,0xbf16bf4f,0xbf163f4f,0x80003f80,0x3f80a554,0xa50dbf80,0xbf80248d
.long 0x80003f80,0x80003f80,0x80003f80,0x80003f80,0xbf733e9e,0xbf80248d,0xbf73be9e,0xbf4fbf16
.long 0xbf16bf4f,0xa50dbf80,0x3f16bf4f,0x3f73be9e,0x3f16bf4f,0x3f80a554,0x3f163f4f,0xbe9e3f73
.long 0x3f733e9e,0x80003f80,0xbf733e9e,0xbf16bf4f,0x80003f80,0xbf80248d,0xa50dbf80,0x3f80a554
.long 0xbf733e9e,0xa50dbf80,0x3f733e9e,0xbf163f4f,0xbf16bf4f,0x3f80a554,0xbf163f4f,0xbe9ebf73
.long 0x3f16bf4f,0x80003f80,0xbf16bf4f,0x3f733e9e,0x3f733e9e,0xbf80248d,0x3f73be9e,0xbf4f3f16
.long 0x80003f80,0xa50dbf80,0x80003f80,0xa50dbf80,0xbf733e9e,0x3f80a554,0xbf73be9e,0x3f4f3f16
.long 0xbf16bf4f,0x80003f80,0x3f16bf4f,0xbf733e9e,0x3f16bf4f,0xbf80248d,0x3f163f4f,0x3e9ebf73
.long 0x3f733e9e,0xa50dbf80,0xbf733e9e,0x3f163f4f,0x80003f80,0x3f80a554,0xa50dbf80,0xbf80248d
.long 0x80003f80,0x80003f80,0x80003f80,0x80003f80,0xbf16bf4f,0xbe9ebf73,0xa50dbf80,0x3e9ebf73
.long 0x3f733e9e,0x3f163f4f,0x80003f80,0xbf163f4f,0xbf733e9e,0xbf4fbf16,0xa50dbf80,0x3f4fbf16
.long 0x3f16bf4f,0x3f733e9e,0x80003f80,0xbf733e9e,0x80003f80,0xbf80248d,0xa50dbf80,0x3f80a554
.long 0xbf16bf4f,0x3f73be9e,0x80003f80,0xbf73be9e,0x3f733e9e,0xbf4f3f16,0xa50dbf80,0x3f4f3f16
.long 0xbf733e9e,0x3f16bf4f,0x80003f80,0xbf16bf4f,0x3f16bf4f,0xbe9e3f73,0xa50dbf80,0x3e9e3f73
.long 0x80003f80,0xa50dbf80,0x80003f80,0xa50dbf80,0xbf16bf4f,0x3e9e3f73,0xa50dbf80,0xbe9e3f73
.long 0x3f733e9e,0xbf16bf4f,0x80003f80,0x3f16bf4f,0xbf733e9e,0x3f4f3f16,0xa50dbf80,0xbf4f3f16
.long 0x3f16bf4f,0xbf73be9e,0x80003f80,0x3f73be9e,0x80003f80,0x3f80a554,0xa50dbf80,0xbf80248d
.long 0x80003f80,0x80003f80,0x80003f80,0x80003f80,0x3f16bf4f,0x3f4fbf16,0x3f73be9e,0x3f80a554
.long 0xbf733e9e,0xbf73be9e,0xbf16bf4f,0xa50dbf80,0x3f733e9e,0x3e9e3f73,0xbf163f4f,0xbf80248d
.long 0xbf16bf4f,0x3f16bf4f,0x3f733e9e,0x80003f80,0x80003f80,0xbf80248d,0xa50dbf80,0x3f80a554
.long 0x3f16bf4f,0x3f163f4f,0xbf733e9e,0xa50dbf80,0xbf733e9e,0x3e9ebf73,0x3f163f4f,0xbf80248d
.long 0x3f733e9e,0xbf733e9e,0x3f16bf4f,0x80003f80,0xbf16bf4f,0x3f4f3f16,0xbf73be9e,0x3f80a554
.long 0x80003f80,0xa50dbf80,0x80003f80,0xa50dbf80,0x3f16bf4f,0xbf4f3f16,0x3f73be9e,0xbf80248d
.long 0xbf733e9e,0x3f733e9e,0xbf16bf4f,0x80003f80,0x3f733e9e,0xbe9ebf73,0xbf163f4f,0x3f80a554
.long 0xbf16bf4f,0xbf163f4f,0x3f733e9e,0xa50dbf80,0x80003f80,0x3f80a554,0xa50dbf80,0xbf80248d
.long 0x80003f80,0x3f733e9e,0x3f16bf4f,0xbf16bf4f,0x80003f80,0x3f4f3f16,0x3f73be9e,0x3e9ebf73
.long 0x80003f80,0x3f163f4f,0x3f733e9e,0x3f73be9e,0x80003f80,0x3e9e3f73,0x3f163f4f,0x3f4f3f16
.long 0x0,0x0,0x0,0x0,0x0,0x0,0x0,0x0
.long 0x0,0x0,0x0,0x0,0x0,0x0,0x0,0x0
.long 0x0,0x0,0x0,0x0,0x0,0x0,0x0,0x0
.long 0x0,0x0,0x0,0x0,0x0,0x0,0x0,0x0
.long 0x0,0x0,0x0,0x0,0x0,0x0,0x0,0x0
.long 0x0,0x0,0x0,0x0,0x0,0x0,0x0,0x0
.long 0xbf733e9e,0x80003f80,0x3f733e9e,0x3f16bf4f,0xbf16bf4f,0xbf80248d,0xbf163f4f,0x3e9e3f73
.long 0x3f16bf4f,0xa50dbf80,0xbf16bf4f,0xbf73be9e,0x3f733e9e,0x3f80a554,0x3f73be9e,0x3f4fbf16
.long 0x0,0x0,0x0,0x0,0x0,0x0,0x0,0x0
.long 0x0,0x0,0x0,0x0,0x0,0x0,0x0,0x0
.long 0x0,0x0,0x0,0x0,0x0,0x0,0x0,0x0
.long 0x0,0x0,0x0,0x0,0x0,0x0,0x0,0x0
.long 0x0,0x0,0x0,0x0,0x0,0x0,0x0,0x0
.long 0x0,0x0,0x0,0x0,0x0,0x0,0x0,0x0
.long 0xbf16bf4f,0xbf733e9e,0x80003f80,0x3f733e9e,0x3f733e9e,0x3f4fbf16,0xa50dbf80,0xbf4fbf16
.long 0xbf733e9e,0xbf163f4f,0x80003f80,0x3f163f4f,0x3f16bf4f,0x3e9ebf73,0xa50dbf80,0xbe9ebf73
.long 0x0,0x0,0x0,0x0,0x0,0x0,0x0,0x0
.long 0x0,0x0,0x0,0x0,0x0,0x0,0x0,0x0
.long 0x0,0x0,0x0,0x0,0x0,0x0,0x0,0x0
.long 0x0,0x0,0x0,0x0,0x0,0x0,0x0,0x0
.long 0x0,0x0,0x0,0x0,0x0,0x0,0x0,0x0
.long 0x0,0x0,0x0,0x0,0x0,0x0,0x0,0x0
.long 0x3f16bf4f,0xbf16bf4f,0xbf733e9e,0x80003f80,0xbf733e9e,0xbe9e3f73,0x3f163f4f,0x3f80a554
.long 0x3f733e9e,0x3f73be9e,0x3f16bf4f,0xa50dbf80,0xbf16bf4f,0xbf4fbf16,0xbf73be9e,0xbf80248d
.long 0x0,0x0,0x0,0x0,0x0,0x0,0x0,0x0
.long 0x0,0x0,0x0,0x0,0x0,0x0,0x0,0x0
.long 0x0,0x0,0x0,0x0,0x0,0x0,0x0,0x0
.long 0x0,0x0,0x0,0x0,0x0,0x0,0x0,0x0
.long 0x0,0x0,0x0,0x0,0x0,0x0,0x0,0x0
.long 0x0,0x0,0x0,0x0,0x0,0x0,0x0,0x0
.long 0x0,0x0,0x0,0x0,0x0,0x0,0x0,0x0
.long 0x0,0x0,0x0,0x0,0x0,0x0,0x0,0x0
.long 0x80003f80,0x3f733e9e,0x3f16bf4f,0xbf16bf4f,0x80003f80,0x3f4f3f16,0x3f73be9e,0x3e9ebf73
.long 0x80003f80,0x3f163f4f,0x3f733e9e,0x3f73be9e,0x80003f80,0x3e9e3f73,0x3f163f4f,0x3f4f3f16
.long 0x0,0x0,0x0,0x0,0x0,0x0,0x0,0x0
.long 0x0,0x0,0x0,0x0,0x0,0x0,0x0,0x0
.long 0x0,0x0,0x0,0x0,0x0,0x0,0x0,0x0
.long 0x0,0x0,0x0,0x0,0x0,0x0,0x0,0x0
.long 0x0,0x0,0x0,0x0,0x0,0x0,0x0,0x0
.long 0x0,0x0,0x0,0x0,0x0,0x0,0x0,0x0
.long 0xbf733e9e,0x80003f80,0x3f733e9e,0x3f16bf4f,0xbf16bf4f,0xbf80248d,0xbf163f4f,0x3e9e3f73
.long 0x3f16bf4f,0xa50dbf80,0xbf16bf4f,0xbf73be9e,0x3f733e9e,0x3f80a554,0x3f73be9e,0x3f4fbf16
.long 0x0,0x0,0x0,0x0,0x0,0x0,0x0,0x0
.long 0x0,0x0,0x0,0x0,0x0,0x0,0x0,0x0
.long 0x0,0x0,0x0,0x0,0x0,0x0,0x0,0x0
.long 0x0,0x0,0x0,0x0,0x0,0x0,0x0,0x0
.long 0x0,0x0,0x0,0x0,0x0,0x0,0x0,0x0
.long 0x0,0x0,0x0,0x0,0x0,0x0,0x0,0x0
.long 0xbf16bf4f,0xbf733e9e,0x80003f80,0x3f733e9e,0x3f733e9e,0x3f4fbf16,0xa50dbf80,0xbf4fbf16
.long 0xbf733e9e,0xbf163f4f,0x80003f80,0x3f163f4f,0x3f16bf4f,0x3e9ebf73,0xa50dbf80,0xbe9ebf73
.long 0x0,0x0,0x0,0x0,0x0,0x0,0x0,0x0
.long 0x0,0x0,0x0,0x0,0x0,0x0,0x0,0x0
.long 0x0,0x0,0x0,0x0,0x0,0x0,0x0,0x0
.long 0x0,0x0,0x0,0x0,0x0,0x0,0x0,0x0
.long 0x0,0x0,0x0,0x0,0x0,0x0,0x0,0x0
.long 0x0,0x0,0x0,0x0,0x0,0x0,0x0,0x0
.long 0x3f16bf4f,0xbf16bf4f,0xbf733e9e,0x80003f80,0xbf733e9e,0xbe9e3f73,0x3f163f4f,0x3f80a554
.long 0x3f733e9e,0x3f73be9e,0x3f16bf4f,0xa50dbf80,0xbf16bf4f,0xbf4fbf16,0xbf73be9e,0xbf80248d
.long 0x0,0x0,0x0,0x0,0x0,0x0,0x0,0x0
.long 0x0,0x0,0x0,0x0,0x0,0x0,0x0,0x0
.long 0x0,0x0,0x0,0x0,0x0,0x0,0x0,0x0
.long 0x0,0x0,0x0,0x0,0x0,0x0,0x0,0x0
p3_tab_end:
```
